```python
import torch

def _softmax(x, axis=-1):
    return torch.softmax(x, dim=axis)
def _gelu(x):
    return torch.nn.functional.gelu(x, approximate="tanh")
def _silu(x):
    return torch.nn.functional.silu(x)
def _sigmoid(x):
    return torch.sigmoid(x)
def _layernorm(x, axis=-1, eps=1e-5):
    m = x.mean(dim=axis, keepdim=True)
    v = x.var(dim=axis, keepdim=True, unbiased=False)
    return (x - m) / torch.sqrt(v + eps)
def _scatter_add(tgt, idx, src, axis=0):
    return tgt.clone().index_add_(axis, idx, src)
def _segment_sum(src, seg, n):
    out = torch.zeros((n,) + src.shape[1:], dtype=src.dtype)
    return out.index_add_(0, seg, src)
def _pad(x, pw):
    flat = tuple(v for pair in reversed(pw) for v in pair)
    return torch.nn.functional.pad(x, flat)

kernel_name = 'gated_mix__sliding_block_cached__gqa_block_cached__decode'

def setup_inputs():

    _w = (lambda a: (lambda t: t.to(torch.bfloat16) if t.is_floating_point() else t)(torch.as_tensor(a)))
    def _A_setup():
        B, Sq, D = 4, 1, 512
        Hq, Hkv, Sk, Dh = 32, 8, 8192, 128
        assert Hq % Hkv == 0, (Hq, Hkv)
        return {
            "x": _w((lambda *s: torch.randn(*s, dtype=torch.bfloat16) * 0.05)(B, Sq, D)),
            "k_cache": _w((lambda *s: torch.randn(*s, dtype=torch.bfloat16) * 6.4)(B, Hkv, Sk, Dh)),
            "v_cache": _w((lambda *s: torch.randn(*s, dtype=torch.bfloat16) * 0.05)(B, Hkv, Sk, Dh)),
            "wq": _w((lambda *s: torch.randn(*s, dtype=torch.bfloat16) * 6.4)(D, Hq * Dh) * (D ** -0.5)),
            "wo": _w((lambda *s: torch.randn(*s, dtype=torch.bfloat16) * 0.05)(Hq * Dh, D) * ((Hq * Dh) ** -0.5)),
        }
    _A_in = _A_setup()

    def _B_setup():
        B, Sq, D = 4, 1, 512
        Hq, Hkv, Sk, Dh = 32, 8, 8192, 128
        assert Hq % Hkv == 0, (Hq, Hkv)
        return {
            "x": _w((lambda *s: torch.randn(*s, dtype=torch.bfloat16) * 0.05)(B, Sq, D)),
            "k_cache": _w((lambda *s: torch.randn(*s, dtype=torch.bfloat16) * 6.4)(B, Hkv, Sk, Dh)),
            "v_cache": _w((lambda *s: torch.randn(*s, dtype=torch.bfloat16) * 0.05)(B, Hkv, Sk, Dh)),
            "wq": _w((lambda *s: torch.randn(*s, dtype=torch.bfloat16) * 6.4)(D, Hq * Dh) * (D ** -0.5)),
            "wo": _w((lambda *s: torch.randn(*s, dtype=torch.bfloat16) * 0.05)(Hq * Dh, D) * ((Hq * Dh) ** -0.5)),
        }
    _B_in = _B_setup()

    return {
        "A_x": _A_in["x"],
        "A_k_cache": _A_in["k_cache"],
        "A_v_cache": _A_in["v_cache"],
        "A_wq": _A_in["wq"],
        "A_wo": _A_in["wo"],
        "B_x": _B_in["x"],
        "B_k_cache": _B_in["k_cache"],
        "B_v_cache": _B_in["v_cache"],
        "B_wq": _B_in["wq"],
        "B_wo": _B_in["wo"],
        "gate_w": _w((lambda *s: torch.randn(*s, dtype=torch.bfloat16) * 0.05)(512) * 16.0),
    }

def reference(A_x, A_k_cache, A_v_cache, A_wq, A_wo, B_x, B_k_cache, B_v_cache, B_wq, B_wo, gate_w):
    def _A_ref(x, k_cache, v_cache, wq, wo):
        B, Sq, D = x.shape
        Hq, Dh = 32, 128
        Hkv, Sk = k_cache.shape[1], k_cache.shape[2]
        W = min(4096, max(256, Sk // 4))
        rep = Hq // Hkv
        q = (lambda x, *d: x.permute(*d))((x @ wq).reshape(B, Sq, Hq, Dh), 0, 2, 1, 3)
        k = (lambda x, n, axis: torch.repeat_interleave(x, n, dim=axis))(k_cache[:, :, Sk - W:, :], rep, axis=1)
        v = (lambda x, n, axis: torch.repeat_interleave(x, n, dim=axis))(v_cache[:, :, Sk - W:, :], rep, axis=1)
        scores = torch.einsum("bhqd,bhkd->bhqk", q, k) * (Dh ** -0.5)
        p = _softmax(scores, axis=-1)
        o = torch.einsum("bhqk,bhkd->bhqd", p, v)
        return (lambda x, *d: x.permute(*d))(o, 0, 2, 1, 3).reshape(B, Sq, Hq * Dh) @ wo

    def _B_ref(x, k_cache, v_cache, wq, wo):
        B, Sq, D = x.shape
        Hq, Dh = 32, 128
        Hkv = k_cache.shape[1]
        rep = Hq // Hkv
        q = (lambda x, *d: x.permute(*d))((x @ wq).reshape(B, Sq, Hq, Dh), 0, 2, 1, 3)
        k = (lambda x, n, axis: torch.repeat_interleave(x, n, dim=axis))(k_cache, rep, axis=1)
        v = (lambda x, n, axis: torch.repeat_interleave(x, n, dim=axis))(v_cache, rep, axis=1)
        scores = torch.einsum("bhqd,bhkd->bhqk", q, k) * (Dh ** -0.5)
        p = _softmax(scores, axis=-1)
        o = torch.einsum("bhqk,bhkd->bhqd", p, v)
        return (lambda x, *d: x.permute(*d))(o, 0, 2, 1, 3).reshape(B, Sq, Hq * Dh) @ wo

    x = A_x
    g = _sigmoid((x * gate_w).sum(-1, keepdims=True))
    a = _A_ref(x, A_k_cache, A_v_cache, A_wq, A_wo)
    b = _B_ref(x, B_k_cache, B_v_cache, B_wq, B_wo)
    return g * a + (1 - g) * b
```

```asm
; @launch grid=(256,1,1) block=(256,1,1) lds=30016
.amdgcn_target "amdgcn-amd-amdhsa--gfx950"
.text
.globl gated_mix__sliding_block_cached__gqa_block_cached__decode_kernel
.p2align 8
.type gated_mix__sliding_block_cached__gqa_block_cached__decode_kernel,@function
gated_mix__sliding_block_cached__gqa_block_cached__decode_kernel:
s_cmp_ge_u32 s2, 256
s_cbranch_scc1 L_end
s_load_dwordx16 s[64:79], s[0:1], 0
s_load_dwordx8 s[80:87], s[0:1], 64
s_load_dwordx4 s[88:91], s[0:1], 96
v_mov_b32 v240, 0
ds_write_b32 v240, v240 offset:28928
v_and_b32 v1, 63, v0
v_lshrrev_b32 v240, 6, v0
s_nop 0
v_readfirstlane_b32 s3, v240
s_and_b32 s48, s2, 7
s_lshr_b32 s92, s2, 3
s_lshl_b32 s93, s48, 2
s_add_u32 s92, s92, s93
s_and_b32 s49, s92, 31
s_lshr_b32 s50, s49, 3
s_and_b32 s51, s49, 7
s_lshl_b32 s52, s48, 2
s_add_u32 s52, s52, s3
s_lshl_b32 s57, s49, 21
s_bfe_u32 s53, s2, 0x10006
s_and_b32 s54, s2, 63
s_and_b32 s96, s2, 127
s_mov_b32 s4, 0x3fb8aa3b
s_mov_b32 s5, 0x3db504f3
s_mov_b32 s6, 0xffff0000
s_mov_b32 s7, 0x3ff
s_mov_b32 s62, 0x05040100
s_mov_b32 s63, 0x07060302
v_lshlrev_b32 v3, 4, v1
v_lshrrev_b32 v241, 4, v1
v_bfe_u32 v242, v1, 2, 2
v_and_b32 v243, 3, v1
v_lshlrev_b32 v2, 6, v241
v_lshl_add_u32 v2, v242, 8, v2
v_lshl_add_u32 v2, v243, 4, v2
v_bfe_u32 v247, v1, 3, 1
v_lshlrev_b32 v244, 17, v241
v_lshl_add_u32 v244, v247, 16, v244
v_and_b32 v242, 7, v1
v_lshl_add_u32 v244, v242, 4, v244
v_lshlrev_b32 v245, 10, v243
v_lshl_add_u32 v245, v241, 5, v245
v_lshl_add_u32 v245, v247, 4, v245
v_and_b32 v246, 15, v1
v_lshlrev_b32 v246, 4, v246
v_lshl_add_u32 v246, v241, 11, v246
v_mov_b32 v4, 1
s_waitcnt lgkmcnt(0)
s_barrier
s_load_dword s55, s[90:91], 0
s_cmp_eq_u32 s53, 0
s_cselect_b32 s92, s70, s80
s_cselect_b32 s93, s71, s81
s_cselect_b32 s94, s72, s82
s_cselect_b32 s95, s73, s83
s_mov_b32 s24, s92
s_and_b32 s25, s93, 0xffff
s_mov_b32 s26, 0x400000
s_mov_b32 s27, 0x20000
s_mov_b32 s32, s64
s_and_b32 s33, s65, 0xffff
s_mov_b32 s34, 0x1000
s_mov_b32 s35, 0x20000
s_mov_b32 s36, s90
s_and_b32 s37, s91, 0xffff
s_mov_b32 s38, 0x11002400
s_mov_b32 s39, 0x20000
s_mov_b32 s8, s66
s_and_b32 s9, s67, 0xffff
s_mov_b32 s10, 0x4000000
s_mov_b32 s11, 0x20000
s_mov_b32 s12, s68
s_and_b32 s13, s69, 0xffff
s_mov_b32 s14, 0x4000000
s_mov_b32 s15, 0x20000
s_mov_b32 s16, s76
s_and_b32 s17, s77, 0xffff
s_mov_b32 s18, 0x4000000
s_mov_b32 s19, 0x20000
s_mov_b32 s20, s78
s_and_b32 s21, s79, 0xffff
s_mov_b32 s22, 0x4000000
s_mov_b32 s23, 0x20000
s_mov_b32 s28, s94
s_and_b32 s29, s95, 0xffff
s_mov_b32 s30, 0x400000
s_mov_b32 s31, 0x20000
s_mov_b32 s44, s84
s_and_b32 s45, s85, 0xffff
s_mov_b32 s46, 0x400
s_mov_b32 s47, 0x20000
s_mov_b32 s40, s86
s_and_b32 s41, s87, 0xffff
s_mov_b32 s42, 0x1000
s_mov_b32 s43, 0x20000
s_lshl_b32 s60, s52, 14
s_add_u32 s60, s60, s57
s_add_u32 s60, s60, 1572864
s_cmp_ge_u32 s2, 128
s_cbranch_scc1 L_opre
s_cmp_lg_u32 s3, 0
s_cbranch_scc1 L_noinit
s_and_b32 s56, s96, 0x47
s_cmp_lg_u32 s56, 0x40
s_cbranch_scc1 L_noinit
s_lshr_b32 s56, s54, 3
s_lshl_b32 s56, s56, 8
s_add_u32 s56, s56, 4096
v_lshlrev_b32 v248, 11, v1
v_mov_b32 v28, 352
s_mov_b32 exec_lo, 0xf
s_mov_b32 exec_hi, 0x0
buffer_store_dword v28, v248, s[36:39], s56 offen offset:0 sc1
s_mov_b64 exec, -1
s_waitcnt vmcnt(0)
L_noinit:
s_lshl_b32 s56, s3, 20
s_lshl_b32 s58, s54, 7
s_add_u32 s56, s56, s58
buffer_load_dwordx4 v[64:67], v244, s[24:27], s56 offen offset:0 nt
s_add_u32 s56, s56, 8192
buffer_load_dwordx4 v[68:71], v244, s[24:27], s56 offen offset:0 nt
s_add_u32 s56, s56, 8192
buffer_load_dwordx4 v[72:75], v244, s[24:27], s56 offen offset:0 nt
s_add_u32 s56, s56, 8192
buffer_load_dwordx4 v[76:79], v244, s[24:27], s56 offen offset:0 nt
s_add_u32 s56, s56, 8192
buffer_load_dwordx4 v[80:83], v244, s[24:27], s56 offen offset:0 nt
s_add_u32 s56, s56, 8192
buffer_load_dwordx4 v[84:87], v244, s[24:27], s56 offen offset:0 nt
s_add_u32 s56, s56, 8192
buffer_load_dwordx4 v[88:91], v244, s[24:27], s56 offen offset:0 nt
s_add_u32 s56, s56, 8192
buffer_load_dwordx4 v[92:95], v244, s[24:27], s56 offen offset:0 nt
s_add_u32 s56, s56, 466944
buffer_load_dwordx4 v[160:163], v244, s[24:27], s56 offen offset:0 nt
s_add_u32 s56, s56, 8192
buffer_load_dwordx4 v[164:167], v244, s[24:27], s56 offen offset:0 nt
s_add_u32 s56, s56, 8192
buffer_load_dwordx4 v[168:171], v244, s[24:27], s56 offen offset:0 nt
s_add_u32 s56, s56, 8192
buffer_load_dwordx4 v[172:175], v244, s[24:27], s56 offen offset:0 nt
s_add_u32 s56, s56, 8192
buffer_load_dwordx4 v[176:179], v244, s[24:27], s56 offen offset:0 nt
s_add_u32 s56, s56, 8192
buffer_load_dwordx4 v[180:183], v244, s[24:27], s56 offen offset:0 nt
s_add_u32 s56, s56, 8192
buffer_load_dwordx4 v[184:187], v244, s[24:27], s56 offen offset:0 nt
s_add_u32 s56, s56, 8192
buffer_load_dwordx4 v[188:191], v244, s[24:27], s56 offen offset:0 nt
s_lshl_b32 s56, s3, 8
buffer_load_dwordx4 v[16:19], v245, s[32:35], s56 offen offset:0
buffer_load_dwordx4 v[248:251], v245, s[32:35], s56 offen offset:128
s_cmp_lg_u32 s3, 0
s_cbranch_scc1 L_nogate
s_lshr_b32 s56, s2, 5
s_lshl_b32 s56, s56, 10
buffer_load_dwordx4 v[216:219], v3, s[32:35], s56 offen offset:0
buffer_load_dwordx4 v[220:223], v3, s[44:47], 0 offen offset:0
s_add_u32 s56, s60, 0
buffer_load_dwordx4 a[0:3], v2, s[8:11], s56 offen offset:0 nt
buffer_load_dwordx4 a[4:7], v2, s[8:11], s56 offen offset:1024 nt
buffer_load_dwordx4 a[8:11], v2, s[8:11], s56 offen offset:2048 nt
buffer_load_dwordx4 a[12:15], v2, s[8:11], s56 offen offset:3072 nt
s_add_u32 s56, s60, 4096
buffer_load_dwordx4 a[16:19], v2, s[8:11], s56 offen offset:0 nt
buffer_load_dwordx4 a[20:23], v2, s[8:11], s56 offen offset:1024 nt
buffer_load_dwordx4 a[24:27], v2, s[8:11], s56 offen offset:2048 nt
buffer_load_dwordx4 a[28:31], v2, s[8:11], s56 offen offset:3072 nt
s_add_u32 s56, s60, 8192
buffer_load_dwordx4 a[32:35], v2, s[8:11], s56 offen offset:0 nt
buffer_load_dwordx4 a[36:39], v2, s[8:11], s56 offen offset:1024 nt
buffer_load_dwordx4 a[40:43], v2, s[8:11], s56 offen offset:2048 nt
buffer_load_dwordx4 a[44:47], v2, s[8:11], s56 offen offset:3072 nt
s_add_u32 s56, s60, 12288
buffer_load_dwordx4 a[48:51], v2, s[8:11], s56 offen offset:0 nt
buffer_load_dwordx4 a[52:55], v2, s[8:11], s56 offen offset:1024 nt
buffer_load_dwordx4 a[56:59], v2, s[8:11], s56 offen offset:2048 nt
buffer_load_dwordx4 a[60:63], v2, s[8:11], s56 offen offset:3072 nt
s_waitcnt vmcnt(18)
s_branch L_qproj
L_nogate:
s_add_u32 s56, s60, 0
buffer_load_dwordx4 a[0:3], v2, s[8:11], s56 offen offset:0 nt
buffer_load_dwordx4 a[4:7], v2, s[8:11], s56 offen offset:1024 nt
buffer_load_dwordx4 a[8:11], v2, s[8:11], s56 offen offset:2048 nt
buffer_load_dwordx4 a[12:15], v2, s[8:11], s56 offen offset:3072 nt
s_add_u32 s56, s60, 4096
buffer_load_dwordx4 a[16:19], v2, s[8:11], s56 offen offset:0 nt
buffer_load_dwordx4 a[20:23], v2, s[8:11], s56 offen offset:1024 nt
buffer_load_dwordx4 a[24:27], v2, s[8:11], s56 offen offset:2048 nt
buffer_load_dwordx4 a[28:31], v2, s[8:11], s56 offen offset:3072 nt
s_add_u32 s56, s60, 8192
buffer_load_dwordx4 a[32:35], v2, s[8:11], s56 offen offset:0 nt
buffer_load_dwordx4 a[36:39], v2, s[8:11], s56 offen offset:1024 nt
buffer_load_dwordx4 a[40:43], v2, s[8:11], s56 offen offset:2048 nt
buffer_load_dwordx4 a[44:47], v2, s[8:11], s56 offen offset:3072 nt
s_add_u32 s56, s60, 12288
buffer_load_dwordx4 a[48:51], v2, s[8:11], s56 offen offset:0 nt
buffer_load_dwordx4 a[52:55], v2, s[8:11], s56 offen offset:1024 nt
buffer_load_dwordx4 a[56:59], v2, s[8:11], s56 offen offset:2048 nt
buffer_load_dwordx4 a[60:63], v2, s[8:11], s56 offen offset:3072 nt
s_waitcnt vmcnt(16)
L_qproj:
v_perm_b32 v224, v68, v64, s62
v_perm_b32 v225, v76, v72, s62
v_perm_b32 v226, v84, v80, s62
v_perm_b32 v227, v92, v88, s62
v_perm_b32 v228, v68, v64, s63
v_perm_b32 v229, v76, v72, s63
v_perm_b32 v230, v84, v80, s63
v_perm_b32 v231, v92, v88, s63
v_mfma_f32_16x16x32_bf16 v[32:35], v[224:227], v[16:19], 0
v_perm_b32 v232, v69, v65, s62
v_perm_b32 v233, v77, v73, s62
v_perm_b32 v234, v85, v81, s62
v_perm_b32 v235, v93, v89, s62
v_mfma_f32_16x16x32_bf16 v[36:39], v[228:231], v[16:19], 0
v_perm_b32 v236, v69, v65, s63
v_perm_b32 v237, v77, v73, s63
v_perm_b32 v238, v85, v81, s63
v_perm_b32 v239, v93, v89, s63
v_mfma_f32_16x16x32_bf16 v[40:43], v[232:235], v[16:19], 0
v_perm_b32 v224, v70, v66, s62
v_perm_b32 v225, v78, v74, s62
v_perm_b32 v226, v86, v82, s62
v_perm_b32 v227, v94, v90, s62
v_mfma_f32_16x16x32_bf16 v[44:47], v[236:239], v[16:19], 0
v_perm_b32 v228, v70, v66, s63
v_perm_b32 v229, v78, v74, s63
v_perm_b32 v230, v86, v82, s63
v_perm_b32 v231, v94, v90, s63
v_mfma_f32_16x16x32_bf16 v[48:51], v[224:227], v[16:19], 0
v_perm_b32 v232, v71, v67, s62
v_perm_b32 v233, v79, v75, s62
v_perm_b32 v234, v87, v83, s62
v_perm_b32 v235, v95, v91, s62
v_mfma_f32_16x16x32_bf16 v[52:55], v[228:231], v[16:19], 0
v_perm_b32 v236, v71, v67, s63
v_perm_b32 v237, v79, v75, s63
v_perm_b32 v238, v87, v83, s63
v_perm_b32 v239, v95, v91, s63
v_mfma_f32_16x16x32_bf16 v[56:59], v[232:235], v[16:19], 0
s_nop 0
v_mfma_f32_16x16x32_bf16 v[60:63], v[236:239], v[16:19], 0
v_perm_b32 v224, v164, v160, s62
v_perm_b32 v225, v172, v168, s62
v_perm_b32 v226, v180, v176, s62
v_perm_b32 v227, v188, v184, s62
v_perm_b32 v228, v164, v160, s63
v_perm_b32 v229, v172, v168, s63
v_perm_b32 v230, v180, v176, s63
v_perm_b32 v231, v188, v184, s63
v_mfma_f32_16x16x32_bf16 v[32:35], v[224:227], v[248:251], v[32:35]
v_perm_b32 v232, v165, v161, s62
v_perm_b32 v233, v173, v169, s62
v_perm_b32 v234, v181, v177, s62
v_perm_b32 v235, v189, v185, s62
v_mfma_f32_16x16x32_bf16 v[36:39], v[228:231], v[248:251], v[36:39]
v_perm_b32 v236, v165, v161, s63
v_perm_b32 v237, v173, v169, s63
v_perm_b32 v238, v181, v177, s63
v_perm_b32 v239, v189, v185, s63
v_mfma_f32_16x16x32_bf16 v[40:43], v[232:235], v[248:251], v[40:43]
v_perm_b32 v224, v166, v162, s62
v_perm_b32 v225, v174, v170, s62
v_perm_b32 v226, v182, v178, s62
v_perm_b32 v227, v190, v186, s62
v_mfma_f32_16x16x32_bf16 v[44:47], v[236:239], v[248:251], v[44:47]
v_perm_b32 v228, v166, v162, s63
v_perm_b32 v229, v174, v170, s63
v_perm_b32 v230, v182, v178, s63
v_perm_b32 v231, v190, v186, s63
v_mfma_f32_16x16x32_bf16 v[48:51], v[224:227], v[248:251], v[48:51]
v_perm_b32 v232, v167, v163, s62
v_perm_b32 v233, v175, v171, s62
v_perm_b32 v234, v183, v179, s62
v_perm_b32 v235, v191, v187, s62
v_mfma_f32_16x16x32_bf16 v[52:55], v[228:231], v[248:251], v[52:55]
v_perm_b32 v236, v167, v163, s63
v_perm_b32 v237, v175, v171, s63
v_perm_b32 v238, v183, v179, s63
v_perm_b32 v239, v191, v187, s63
v_mfma_f32_16x16x32_bf16 v[56:59], v[232:235], v[248:251], v[56:59]
s_nop 0
v_mfma_f32_16x16x32_bf16 v[60:63], v[236:239], v[248:251], v[60:63]
v_lshrrev_b32 v28, 5, v1
v_lshlrev_b32 v28, 10, v28
v_and_b32 v29, 3, v1
v_lshl_add_u32 v28, v29, 8, v28
v_bfe_u32 v29, v1, 4, 1
v_lshl_add_u32 v28, v29, 4, v28
s_lshl_b32 s92, s3, 11
v_add_u32 v28, s92, v28
s_mov_b32 exec_lo, 0xf000f
s_mov_b32 exec_hi, 0xf000f00
ds_write_b128 v28, v[32:35] offset:0
ds_write_b128 v28, v[36:39] offset:32
ds_write_b128 v28, v[40:43] offset:64
ds_write_b128 v28, v[44:47] offset:96
ds_write_b128 v28, v[48:51] offset:128
ds_write_b128 v28, v[52:55] offset:160
ds_write_b128 v28, v[56:59] offset:192
ds_write_b128 v28, v[60:63] offset:224
s_mov_b64 exec, -1
s_waitcnt lgkmcnt(0)
s_add_u32 s55, s55, 0x9e3779b1
s_barrier
v_and_b32 v28, 7, v1
v_lshrrev_b32 v29, 3, v1
v_lshl_add_u32 v28, v28, 3, v29
v_lshlrev_b32 v28, 2, v28
s_lshl_b32 s92, s3, 8
v_add_u32 v28, s92, v28
ds_read_b32 v32, v28 offset:0
ds_read_b32 v33, v28 offset:1024
ds_read_b32 v34, v28 offset:2048
ds_read_b32 v35, v28 offset:3072
ds_read_b32 v36, v28 offset:4096
ds_read_b32 v37, v28 offset:5120
ds_read_b32 v38, v28 offset:6144
ds_read_b32 v39, v28 offset:7168
v_lshlrev_b32 v30, 2, v1
v_add_u32 v30, s92, v30
v_add_u32 v29, s92, v3
s_lshl_b32 s92, s53, 16
s_lshl_b32 s93, s54, 8
s_add_u32 s92, s92, s93
s_lshl_b32 s93, s3, 14
s_add_u32 s92, s92, s93
s_add_u32 s56, s92, 65536
v_mov_b32 v31, s55
s_mov_b32 s92, 0x07060100
s_waitcnt lgkmcnt(0)
v_add_f32 v32, v32, v33
v_add_f32 v34, v34, v35
v_add_f32 v36, v36, v37
v_add_f32 v38, v38, v39
v_add_f32 v32, v32, v34
v_add_f32 v36, v36, v38
v_add_f32 v32, v32, v36
v_cvt_pk_bf16_f32 v32, v32, v32
v_perm_b32 v32, v32, v31, s92
ds_write_b32 v30, v32 offset:28992
s_waitcnt lgkmcnt(0)
s_mov_b64 exec, 0xffff
ds_read_b128 v[224:227], v29 offset:28992
s_waitcnt lgkmcnt(0)
buffer_store_dwordx4 v[224:227], v3, s[36:39], s56 offen offset:0 sc1
s_mov_b64 exec, -1
s_mul_i32 s58, s49, 8
s_add_u32 s58, s58, s52
s_and_b32 s58, s58, 511
s_lshl_b32 s58, s58, 12
s_add_u32 s58, s58, s57
buffer_load_dwordx4 a[64:67], v2, s[16:19], s58 offen offset:0 nt
buffer_load_dwordx4 a[68:71], v2, s[16:19], s58 offen offset:1024 nt
buffer_load_dwordx4 a[72:75], v2, s[16:19], s58 offen offset:2048 nt
buffer_load_dwordx4 a[76:79], v2, s[16:19], s58 offen offset:3072 nt
buffer_load_dwordx4 v[192:195], v3, s[20:23], s58 offen offset:0 nt
buffer_load_dwordx4 v[196:199], v3, s[20:23], s58 offen offset:1024 nt
buffer_load_dwordx4 v[200:203], v3, s[20:23], s58 offen offset:2048 nt
buffer_load_dwordx4 v[204:207], v3, s[20:23], s58 offen offset:3072 nt
s_add_u32 s56, s60, 0
buffer_load_dwordx4 v[96:99], v3, s[12:15], s56 offen offset:0 nt
buffer_load_dwordx4 v[100:103], v3, s[12:15], s56 offen offset:1024 nt
buffer_load_dwordx4 v[104:107], v3, s[12:15], s56 offen offset:2048 nt
buffer_load_dwordx4 v[108:111], v3, s[12:15], s56 offen offset:3072 nt
s_add_u32 s56, s60, 4096
buffer_load_dwordx4 v[112:115], v3, s[12:15], s56 offen offset:0 nt
buffer_load_dwordx4 v[116:119], v3, s[12:15], s56 offen offset:1024 nt
buffer_load_dwordx4 v[120:123], v3, s[12:15], s56 offen offset:2048 nt
buffer_load_dwordx4 v[124:127], v3, s[12:15], s56 offen offset:3072 nt
s_add_u32 s56, s60, 8192
buffer_load_dwordx4 v[128:131], v3, s[12:15], s56 offen offset:0 nt
buffer_load_dwordx4 v[132:135], v3, s[12:15], s56 offen offset:1024 nt
buffer_load_dwordx4 v[136:139], v3, s[12:15], s56 offen offset:2048 nt
buffer_load_dwordx4 v[140:143], v3, s[12:15], s56 offen offset:3072 nt
s_add_u32 s56, s60, 12288
buffer_load_dwordx4 v[144:147], v3, s[12:15], s56 offen offset:0 nt
buffer_load_dwordx4 v[148:151], v3, s[12:15], s56 offen offset:1024 nt
buffer_load_dwordx4 v[152:155], v3, s[12:15], s56 offen offset:2048 nt
buffer_load_dwordx4 v[156:159], v3, s[12:15], s56 offen offset:3072 nt
s_cmp_lg_u32 s3, 0
s_cbranch_scc1 L_qwait
s_waitcnt vmcnt(41)
v_mov_b32 v10, 0
v_lshlrev_b32 v28, 16, v216
v_and_b32 v29, s6, v216
v_lshlrev_b32 v30, 16, v220
v_and_b32 v31, s6, v220
v_mul_f32 v28, v28, v30
v_mul_f32 v29, v29, v31
v_cvt_pk_bf16_f32 v28, v28, v29
v_lshlrev_b32 v29, 16, v28
v_and_b32 v28, s6, v28
v_add_f32 v10, v10, v29
v_add_f32 v10, v10, v28
v_lshlrev_b32 v28, 16, v217
v_and_b32 v29, s6, v217
v_lshlrev_b32 v30, 16, v221
v_and_b32 v31, s6, v221
v_mul_f32 v28, v28, v30
v_mul_f32 v29, v29, v31
v_cvt_pk_bf16_f32 v28, v28, v29
v_lshlrev_b32 v29, 16, v28
v_and_b32 v28, s6, v28
v_add_f32 v10, v10, v29
v_add_f32 v10, v10, v28
v_lshlrev_b32 v28, 16, v218
v_and_b32 v29, s6, v218
v_lshlrev_b32 v30, 16, v222
v_and_b32 v31, s6, v222
v_mul_f32 v28, v28, v30
v_mul_f32 v29, v29, v31
v_cvt_pk_bf16_f32 v28, v28, v29
v_lshlrev_b32 v29, 16, v28
v_and_b32 v28, s6, v28
v_add_f32 v10, v10, v29
v_add_f32 v10, v10, v28
v_lshlrev_b32 v28, 16, v219
v_and_b32 v29, s6, v219
v_lshlrev_b32 v30, 16, v223
v_and_b32 v31, s6, v223
v_mul_f32 v28, v28, v30
v_mul_f32 v29, v29, v31
v_cvt_pk_bf16_f32 v28, v28, v29
v_lshlrev_b32 v29, 16, v28
v_and_b32 v28, s6, v28
v_add_f32 v10, v10, v29
v_add_f32 v10, v10, v28
s_nop 1
v_add_f32_dpp v10, v10, v10 quad_perm:[1,0,3,2] row_mask:0xf bank_mask:0xf
s_nop 1
v_add_f32_dpp v10, v10, v10 quad_perm:[2,3,0,1] row_mask:0xf bank_mask:0xf
s_nop 1
v_add_f32_dpp v10, v10, v10 row_half_mirror row_mask:0xf bank_mask:0xf
s_nop 1
v_add_f32_dpp v10, v10, v10 row_mirror row_mask:0xf bank_mask:0xf
s_nop 1
v_add_f32_dpp v10, v10, v10 row_bcast:15 row_mask:0xa bank_mask:0xf
s_nop 1
v_add_f32_dpp v10, v10, v10 row_bcast:31 row_mask:0xc bank_mask:0xf
s_nop 0
v_readlane_b32 s92, v10, 63
s_nop 1
v_mov_b32 v28, s92
v_cvt_pk_bf16_f32 v28, v28, v28
v_and_b32 v28, s6, v28
v_mul_f32 v28, s4, v28
v_sub_f32 v28, 0, v28
v_exp_f32 v28, v28
s_nop 0
v_add_f32 v28, 1.0, v28
v_rcp_f32 v28, v28
s_nop 0
v_cvt_pk_bf16_f32 v28, v28, v28
v_and_b32 v28, s6, v28
v_sub_f32 v29, 1.0, v28
v_cvt_pk_bf16_f32 v29, v29, v29
v_and_b32 v29, s6, v29
v_readfirstlane_b32 s97, v28
v_readfirstlane_b32 s98, v29
s_branch L_qpoll
L_opre:
s_add_u32 s56, s60, 0
buffer_load_dwordx4 a[0:3], v2, s[8:11], s56 offen offset:0 nt
buffer_load_dwordx4 a[4:7], v2, s[8:11], s56 offen offset:1024 nt
buffer_load_dwordx4 a[8:11], v2, s[8:11], s56 offen offset:2048 nt
buffer_load_dwordx4 a[12:15], v2, s[8:11], s56 offen offset:3072 nt
s_add_u32 s56, s60, 4096
buffer_load_dwordx4 a[16:19], v2, s[8:11], s56 offen offset:0 nt
buffer_load_dwordx4 a[20:23], v2, s[8:11], s56 offen offset:1024 nt
buffer_load_dwordx4 a[24:27], v2, s[8:11], s56 offen offset:2048 nt
buffer_load_dwordx4 a[28:31], v2, s[8:11], s56 offen offset:3072 nt
s_add_u32 s56, s60, 8192
buffer_load_dwordx4 a[32:35], v2, s[8:11], s56 offen offset:0 nt
buffer_load_dwordx4 a[36:39], v2, s[8:11], s56 offen offset:1024 nt
buffer_load_dwordx4 a[40:43], v2, s[8:11], s56 offen offset:2048 nt
buffer_load_dwordx4 a[44:47], v2, s[8:11], s56 offen offset:3072 nt
s_add_u32 s56, s60, 12288
buffer_load_dwordx4 a[48:51], v2, s[8:11], s56 offen offset:0 nt
buffer_load_dwordx4 a[52:55], v2, s[8:11], s56 offen offset:1024 nt
buffer_load_dwordx4 a[56:59], v2, s[8:11], s56 offen offset:2048 nt
buffer_load_dwordx4 a[60:63], v2, s[8:11], s56 offen offset:3072 nt
s_mul_i32 s58, s49, 8
s_add_u32 s58, s58, s52
s_and_b32 s58, s58, 511
s_lshl_b32 s58, s58, 12
s_add_u32 s58, s58, s57
buffer_load_dwordx4 a[64:67], v2, s[16:19], s58 offen offset:0 nt
buffer_load_dwordx4 a[68:71], v2, s[16:19], s58 offen offset:1024 nt
buffer_load_dwordx4 a[72:75], v2, s[16:19], s58 offen offset:2048 nt
buffer_load_dwordx4 a[76:79], v2, s[16:19], s58 offen offset:3072 nt
buffer_load_dwordx4 v[192:195], v3, s[20:23], s58 offen offset:0 nt
buffer_load_dwordx4 v[196:199], v3, s[20:23], s58 offen offset:1024 nt
buffer_load_dwordx4 v[200:203], v3, s[20:23], s58 offen offset:2048 nt
buffer_load_dwordx4 v[204:207], v3, s[20:23], s58 offen offset:3072 nt
s_waitcnt lgkmcnt(0)
s_add_u32 s55, s55, 0x9e3779b1
s_add_u32 s56, s60, 0
buffer_load_dwordx4 v[96:99], v3, s[12:15], s56 offen offset:0 nt
buffer_load_dwordx4 v[100:103], v3, s[12:15], s56 offen offset:1024 nt
buffer_load_dwordx4 v[104:107], v3, s[12:15], s56 offen offset:2048 nt
buffer_load_dwordx4 v[108:111], v3, s[12:15], s56 offen offset:3072 nt
s_add_u32 s56, s60, 4096
buffer_load_dwordx4 v[112:115], v3, s[12:15], s56 offen offset:0 nt
buffer_load_dwordx4 v[116:119], v3, s[12:15], s56 offen offset:1024 nt
buffer_load_dwordx4 v[120:123], v3, s[12:15], s56 offen offset:2048 nt
buffer_load_dwordx4 v[124:127], v3, s[12:15], s56 offen offset:3072 nt
s_add_u32 s56, s60, 8192
buffer_load_dwordx4 v[128:131], v3, s[12:15], s56 offen offset:0 nt
buffer_load_dwordx4 v[132:135], v3, s[12:15], s56 offen offset:1024 nt
buffer_load_dwordx4 v[136:139], v3, s[12:15], s56 offen offset:2048 nt
buffer_load_dwordx4 v[140:143], v3, s[12:15], s56 offen offset:3072 nt
s_add_u32 s56, s60, 12288
buffer_load_dwordx4 v[144:147], v3, s[12:15], s56 offen offset:0 nt
buffer_load_dwordx4 v[148:151], v3, s[12:15], s56 offen offset:1024 nt
buffer_load_dwordx4 v[152:155], v3, s[12:15], s56 offen offset:2048 nt
buffer_load_dwordx4 v[156:159], v3, s[12:15], s56 offen offset:3072 nt
s_cmp_eq_u32 s3, 0
s_cbranch_scc1 L_qpoll
s_lshl_b32 s92, s54, 16
s_lshl_b32 s93, s3, 8
s_add_u32 s92, s92, s93
s_add_u32 s56, s92, 0
buffer_load_dwordx4 a[132:135], v246, s[28:31], s56 offen offset:0 nt
s_add_u32 s56, s92, 8192
buffer_load_dwordx4 a[136:139], v246, s[28:31], s56 offen offset:0 nt
s_add_u32 s56, s92, 16384
buffer_load_dwordx4 a[140:143], v246, s[28:31], s56 offen offset:0 nt
s_add_u32 s56, s92, 24576
buffer_load_dwordx4 a[144:147], v246, s[28:31], s56 offen offset:0 nt
s_add_u32 s56, s92, 1024
buffer_load_dwordx4 a[148:151], v246, s[28:31], s56 offen offset:0 nt
s_add_u32 s56, s92, 9216
buffer_load_dwordx4 a[152:155], v246, s[28:31], s56 offen offset:0 nt
s_add_u32 s56, s92, 17408
buffer_load_dwordx4 a[156:159], v246, s[28:31], s56 offen offset:0 nt
s_add_u32 s56, s92, 25600
buffer_load_dwordx4 a[160:163], v246, s[28:31], s56 offen offset:0 nt
s_add_u32 s56, s92, 32768
buffer_load_dwordx4 a[164:167], v246, s[28:31], s56 offen offset:0 nt
s_add_u32 s56, s92, 40960
buffer_load_dwordx4 a[168:171], v246, s[28:31], s56 offen offset:0 nt
s_add_u32 s56, s92, 49152
buffer_load_dwordx4 a[172:175], v246, s[28:31], s56 offen offset:0 nt
s_add_u32 s56, s92, 57344
buffer_load_dwordx4 a[176:179], v246, s[28:31], s56 offen offset:0 nt
s_add_u32 s56, s92, 33792
buffer_load_dwordx4 a[180:183], v246, s[28:31], s56 offen offset:0 nt
s_add_u32 s56, s92, 41984
buffer_load_dwordx4 a[184:187], v246, s[28:31], s56 offen offset:0 nt
s_add_u32 s56, s92, 50176
buffer_load_dwordx4 a[188:191], v246, s[28:31], s56 offen offset:0 nt
s_add_u32 s56, s92, 58368
buffer_load_dwordx4 a[192:195], v246, s[28:31], s56 offen offset:0 nt
s_branch L_qwait
L_qpoll:
s_lshl_b32 s92, s50, 14
s_lshl_b32 s93, s51, 11
s_add_u32 s92, s92, s93
s_add_u32 s92, s92, 65536
s_add_u32 s93, s92, 65536
v_bfe_u32 v28, v1, 3, 2
v_lshlrev_b32 v28, 8, v28
v_bfe_u32 v29, v1, 1, 2
v_lshl_add_u32 v28, v29, 6, v28
v_lshrrev_b32 v29, 5, v1
v_lshl_add_u32 v28, v29, 4, v28
v_and_b32 v29, 1, v1
v_lshl_add_u32 v28, v29, 3, v28
s_mov_b32 s61, 0
L_poll_1:
buffer_load_dwordx4 v[208:211], v3, s[36:39], s92 offen offset:0 sc1
buffer_load_dwordx4 v[212:215], v3, s[36:39], s92 offen offset:1024 sc1
buffer_load_dwordx4 v[216:219], v3, s[36:39], s93 offen offset:0 sc1
buffer_load_dwordx4 v[220:223], v3, s[36:39], s93 offen offset:1024 sc1
s_add_u32 s61, s61, 1
s_waitcnt vmcnt(0)
L_pollc_2:
v_xor_b32 v252, s55, v208
v_xor_b32 v253, s55, v209
v_xor_b32 v254, s55, v210
v_or3_b32 v252, v252, v253, v254
v_xor_b32 v253, s55, v211
v_xor_b32 v254, s55, v212
v_or3_b32 v252, v252, v253, v254
v_xor_b32 v253, s55, v213
v_xor_b32 v254, s55, v214
v_or3_b32 v252, v252, v253, v254
v_xor_b32 v253, s55, v215
v_xor_b32 v254, s55, v216
v_or3_b32 v252, v252, v253, v254
v_xor_b32 v253, s55, v217
v_xor_b32 v254, s55, v218
v_or3_b32 v252, v252, v253, v254
v_xor_b32 v253, s55, v219
v_xor_b32 v254, s55, v220
v_or3_b32 v252, v252, v253, v254
v_xor_b32 v253, s55, v221
v_xor_b32 v254, s55, v222
v_or3_b32 v252, v252, v253, v254
v_xor_b32 v253, s55, v223
v_or_b32 v252, v252, v253
v_and_b32 v252, 0xffff, v252
v_cmp_ne_u32 vcc, 0, v252
s_nop 0
s_cbranch_vccz L_polled_3
s_mov_b64 exec, vcc
s_cmp_lt_u32 s61, 200000
s_cbranch_scc1 L_poll_1
L_polled_3:
s_mov_b64 exec, -1
v_perm_b32 v224, v209, v208, s63
v_perm_b32 v225, v211, v210, s63
v_perm_b32 v226, v213, v212, s63
v_perm_b32 v227, v215, v214, s63
v_perm_b32 v228, v217, v216, s63
v_perm_b32 v229, v219, v218, s63
v_perm_b32 v230, v221, v220, s63
v_perm_b32 v231, v223, v222, s63
ds_write_b64 v28, v[224:225] offset:8192
ds_write_b64 v28, v[226:227] offset:8224
ds_write_b64 v28, v[228:229] offset:9216
ds_write_b64 v28, v[230:231] offset:9248
s_waitcnt lgkmcnt(0)
v_mov_b32 v28, 0
v_mov_b32 v29, 1
ds_write_b32 v28, v29 offset:28928
s_cmp_lt_u32 s2, 128
s_cbranch_scc1 L_aphase
s_lshl_b32 s92, s54, 16
s_lshl_b32 s93, s3, 8
s_add_u32 s92, s92, s93
s_add_u32 s56, s92, 0
buffer_load_dwordx4 a[132:135], v246, s[28:31], s56 offen offset:0 nt
s_add_u32 s56, s92, 8192
buffer_load_dwordx4 a[136:139], v246, s[28:31], s56 offen offset:0 nt
s_add_u32 s56, s92, 16384
buffer_load_dwordx4 a[140:143], v246, s[28:31], s56 offen offset:0 nt
s_add_u32 s56, s92, 24576
buffer_load_dwordx4 a[144:147], v246, s[28:31], s56 offen offset:0 nt
s_add_u32 s56, s92, 1024
buffer_load_dwordx4 a[148:151], v246, s[28:31], s56 offen offset:0 nt
s_add_u32 s56, s92, 9216
buffer_load_dwordx4 a[152:155], v246, s[28:31], s56 offen offset:0 nt
s_add_u32 s56, s92, 17408
buffer_load_dwordx4 a[156:159], v246, s[28:31], s56 offen offset:0 nt
s_add_u32 s56, s92, 25600
buffer_load_dwordx4 a[160:163], v246, s[28:31], s56 offen offset:0 nt
s_add_u32 s56, s92, 32768
buffer_load_dwordx4 a[164:167], v246, s[28:31], s56 offen offset:0 nt
s_add_u32 s56, s92, 40960
buffer_load_dwordx4 a[168:171], v246, s[28:31], s56 offen offset:0 nt
s_add_u32 s56, s92, 49152
buffer_load_dwordx4 a[172:175], v246, s[28:31], s56 offen offset:0 nt
s_add_u32 s56, s92, 57344
buffer_load_dwordx4 a[176:179], v246, s[28:31], s56 offen offset:0 nt
s_add_u32 s56, s92, 33792
buffer_load_dwordx4 a[180:183], v246, s[28:31], s56 offen offset:0 nt
s_add_u32 s56, s92, 41984
buffer_load_dwordx4 a[184:187], v246, s[28:31], s56 offen offset:0 nt
s_add_u32 s56, s92, 50176
buffer_load_dwordx4 a[188:191], v246, s[28:31], s56 offen offset:0 nt
s_add_u32 s56, s92, 58368
buffer_load_dwordx4 a[192:195], v246, s[28:31], s56 offen offset:0 nt
s_branch L_aphase
L_qwait:
v_mov_b32 v28, 0
s_mov_b32 s61, 0
L_flagq:
ds_read_b32 v29, v28 offset:28928
s_add_u32 s61, s61, 1
s_waitcnt lgkmcnt(0)
v_readfirstlane_b32 s92, v29
s_nop 0
s_cmp_eq_u32 s92, 1
s_cbranch_scc1 L_aphase
s_cmp_lt_u32 s61, 0x400000
s_cbranch_scc1 L_flagq
L_aphase:
ds_read_b128 v[24:27], v3 offset:9216
ds_read_b128 v[20:23], v3 offset:8192
s_add_u32 s92, s52, 32
s_mul_i32 s58, s49, 8
s_add_u32 s58, s58, s92
s_and_b32 s58, s58, 511
s_lshl_b32 s58, s58, 12
s_add_u32 s58, s58, s57
s_add_u32 s92, s52, 64
v_mov_b32 v6, s92
s_lshl_b32 s92, s49, 8
s_add_u32 s92, s92, 4096
v_mov_b32 v5, s92
s_cmp_ge_u32 s2, 128
s_cbranch_scc1 L_wl_4
s_waitcnt vmcnt(20) lgkmcnt(1)
s_branch L_wh_5
L_wl_4:
s_waitcnt vmcnt(36) lgkmcnt(1)
L_wh_5:
v_mfma_f32_16x16x32_bf16 v[208:211], a[64:67], v[24:27], 0
v_mfma_f32_16x16x32_bf16 v[212:215], a[68:71], v[24:27], 0
v_mfma_f32_16x16x32_bf16 v[216:219], a[72:75], v[24:27], 0
v_mfma_f32_16x16x32_bf16 v[220:223], a[76:79], v[24:27], 0
buffer_load_dwordx4 a[64:67], v2, s[16:19], s58 offen offset:0 nt
buffer_load_dwordx4 a[68:71], v2, s[16:19], s58 offen offset:1024 nt
buffer_load_dwordx4 a[72:75], v2, s[16:19], s58 offen offset:2048 nt
buffer_load_dwordx4 a[76:79], v2, s[16:19], s58 offen offset:3072 nt
s_nop 0
v_mov_b32_dpp v12, v208 quad_perm:[0,1,2,3] row_mask:0xf bank_mask:0x1
v_mov_b32_dpp v13, v209 row_ror:12 row_mask:0xf bank_mask:0x1
v_mov_b32_dpp v14, v210 row_ror:8 row_mask:0xf bank_mask:0x1
v_mov_b32_dpp v15, v211 row_ror:4 row_mask:0xf bank_mask:0x1
v_mov_b32_dpp v12, v212 row_ror:4 row_mask:0xf bank_mask:0x2
v_mov_b32_dpp v13, v213 quad_perm:[0,1,2,3] row_mask:0xf bank_mask:0x2
v_mov_b32_dpp v14, v214 row_ror:12 row_mask:0xf bank_mask:0x2
v_mov_b32_dpp v15, v215 row_ror:8 row_mask:0xf bank_mask:0x2
v_mov_b32_dpp v12, v216 row_ror:8 row_mask:0xf bank_mask:0x4
v_mov_b32_dpp v13, v217 row_ror:4 row_mask:0xf bank_mask:0x4
v_mov_b32_dpp v14, v218 quad_perm:[0,1,2,3] row_mask:0xf bank_mask:0x4
v_mov_b32_dpp v15, v219 row_ror:12 row_mask:0xf bank_mask:0x4
v_mov_b32_dpp v12, v220 row_ror:12 row_mask:0xf bank_mask:0x8
v_mov_b32_dpp v13, v221 row_ror:8 row_mask:0xf bank_mask:0x8
v_mov_b32_dpp v14, v222 row_ror:4 row_mask:0xf bank_mask:0x8
v_mov_b32_dpp v15, v223 quad_perm:[0,1,2,3] row_mask:0xf bank_mask:0x8
v_add_f32 v12, v12, v13
v_add_f32 v14, v14, v15
v_add_f32 v10, v12, v14
v_cvt_pk_bf16_f32 v10, v10, v10
v_and_b32 v10, s6, v10
v_mul_f32 v10, s5, v10
v_cvt_pk_bf16_f32 v10, v10, v10
v_and_b32 v10, s6, v10
v_mov_b32 v7, v10
s_nop 1
v_max_f32_dpp v7, v7, v7 row_ror:4 row_mask:0xf bank_mask:0xf
s_nop 1
v_max_f32_dpp v7, v7, v7 row_ror:8 row_mask:0xf bank_mask:0xf
v_mov_b32 v28, v7
s_nop 1
v_permlane16_swap_b32 v7, v28
v_max_f32 v7, v7, v28
v_mov_b32 v28, v7
s_nop 1
v_permlane32_swap_b32 v7, v28
v_max_f32 v7, v7, v28
v_mul_f32 v8, s4, v7
v_fma_f32 v9, v10, s4, -v8
v_exp_f32 v9, v9
s_nop 1
v_mov_b32_dpp v29, v9 row_shl:4 row_mask:0xf bank_mask:0xf bound_ctrl:0
v_mov_b32_dpp v30, v9 row_shl:8 row_mask:0xf bank_mask:0xf bound_ctrl:0
v_mov_b32_dpp v31, v9 row_shl:12 row_mask:0xf bank_mask:0xf bound_ctrl:0
v_cvt_pk_bf16_f32 v16, v9, v29
v_cvt_pk_bf16_f32 v17, v30, v31
s_cmp_ge_u32 s2, 128
s_cbranch_scc1 L_wl_6
s_waitcnt vmcnt(20)
s_branch L_wh_7
L_wl_6:
s_waitcnt vmcnt(36)
L_wh_7:
v_perm_b32 v224, v196, v192, s62
v_perm_b32 v225, v204, v200, s62
v_perm_b32 v226, v196, v192, s63
v_perm_b32 v227, v204, v200, s63
v_perm_b32 v228, v197, v193, s62
v_perm_b32 v229, v205, v201, s62
v_perm_b32 v230, v197, v193, s63
v_perm_b32 v231, v205, v201, s63
v_perm_b32 v232, v198, v194, s62
v_perm_b32 v233, v206, v202, s62
v_perm_b32 v234, v198, v194, s63
v_perm_b32 v235, v206, v202, s63
v_perm_b32 v236, v199, v195, s62
v_perm_b32 v237, v207, v203, s62
v_perm_b32 v238, v199, v195, s63
v_perm_b32 v239, v207, v203, s63
buffer_load_dwordx4 v[192:195], v3, s[20:23], s58 offen offset:0 nt
buffer_load_dwordx4 v[196:199], v3, s[20:23], s58 offen offset:1024 nt
buffer_load_dwordx4 v[200:203], v3, s[20:23], s58 offen offset:2048 nt
buffer_load_dwordx4 v[204:207], v3, s[20:23], s58 offen offset:3072 nt
v_mfma_f32_16x16x16_bf16 v[32:35], v[224:225], v[16:17], 0
v_mfma_f32_16x16x16_bf16 v[36:39], v[226:227], v[16:17], 0
v_mfma_f32_16x16x16_bf16 v[40:43], v[228:229], v[16:17], 0
v_mfma_f32_16x16x16_bf16 v[44:47], v[230:231], v[16:17], 0
v_mfma_f32_16x16x16_bf16 v[48:51], v[232:233], v[16:17], 0
v_mfma_f32_16x16x16_bf16 v[52:55], v[234:235], v[16:17], 0
v_mfma_f32_16x16x16_bf16 v[56:59], v[236:237], v[16:17], 0
v_mfma_f32_16x16x16_bf16 v[60:63], v[238:239], v[16:17], 0
v_and_b32 v28, 3, v1
v_lshrrev_b32 v29, 4, v1
v_bfe_u32 v30, v1, 2, 2
v_mul_u32_u24 v80, 528, v28
v_lshl_add_u32 v80, v29, 7, v80
s_mul_i32 s92, s3, 2112
v_add_u32 v80, s92, v80
v_lshlrev_b32 v81, 5, v1
s_lshl_b32 s92, s3, 2
v_add_u32 v81, s92, v81
v_lshlrev_b32 v89, 7, v30
v_lshl_add_u32 v89, v29, 4, v89
v_lshlrev_b32 v92, 6, v29
v_lshl_add_u32 v92, v28, 4, v92
s_lshl_b32 s92, s3, 8
v_add_u32 v92, s92, v92
v_and_b32 v31, 15, v1
v_lshlrev_b32 v93, 2, v31
v_lshlrev_b32 v94, 1, v31
s_lshl_b32 s44, s96, 5
v_lshlrev_b32 v31, 5, v30
v_lshl_add_u32 v31, v29, 1, v31
s_lshl_b32 s92, s3, 3
s_add_u32 s93, s92, s96
v_lshlrev_b32 v28, 4, v28
v_add_u32 v90, s93, v31
v_and_b32 v90, 63, v90
v_lshl_add_u32 v90, v90, 6, v28
v_lshl_add_u32 v90, v31, 13, v90
v_add_u32 v31, 1, v31
v_add_u32 v91, s93, v31
v_and_b32 v91, 63, v91
v_lshl_add_u32 v91, v91, 6, v28
v_lshl_add_u32 v91, v31, 13, v91
s_lshl_b32 s92, s3, 16
s_and_b32 s93, s96, 64
s_lshl_b32 s93, s93, 6
s_add_u32 s92, s92, s93
s_add_u32 s26, s92, 2097152
s_lshl_b32 s92, s96, 13
s_lshl_b32 s93, s3, 11
s_add_u32 s93, s92, s93
s_add_u32 s27, s93, 2097152
s_add_u32 s24, s92, 262144
s_lshl_b32 s92, s96, 9
s_add_u32 s25, s92, 1310720
v_lshrrev_b32 v28, 4, v1
s_lshl_b32 s93, s3, 3
s_add_u32 s93, s93, s96
v_add_u32 v28, s93, v28
v_add_u32 v29, 4, v28
v_and_b32 v28, 31, v28
v_and_b32 v29, 31, v29
v_and_b32 v30, 15, v1
v_lshlrev_b32 v87, 4, v28
v_lshlrev_b32 v245, 4, v29
v_lshlrev_b32 v86, 8, v28
v_lshl_add_u32 v86, v30, 4, v86
v_lshlrev_b32 v244, 8, v29
v_lshl_add_u32 v244, v30, 4, v244
v_lshlrev_b32 v88, 3, v30
s_lshl_b32 s92, s3, 7
v_add_u32 v88, s92, v88
v_lshrrev_b32 v28, 7, v0
v_bfe_u32 v29, v0, 5, 2
v_bfe_u32 v30, v0, 3, 2
v_and_b32 v31, 7, v0
v_lshl_add_u32 v82, v28, 2, v29
v_lshlrev_b32 v82, 5, v82
v_mul_u32_u24 v83, 8448, v28
v_mul_u32_u24 v240, 528, v29
v_add_u32 v83, v83, v240
v_lshl_add_u32 v83, v31, 4, v83
v_lshl_add_u32 v83, v30, 7, v83
v_lshlrev_b32 v240, 6, v28
v_lshl_add_u32 v240, v29, 1, v240
v_lshrrev_b32 v28, 1, v30
v_add_u32 v240, v240, v28
s_lshl_b32 s92, s51, 3
v_add_u32 v240, s92, v240
s_lshl_b32 s93, s50, 3
s_add_u32 s93, s93, s48
v_add_u32 v28, s93, v240
v_and_b32 v28, 31, v28
v_lshlrev_b32 v85, 9, v240
v_lshl_add_u32 v85, v28, 4, v85
v_add_u32 v85, 1310720, v85
v_lshlrev_b32 v84, 13, v240
v_lshl_add_u32 v84, v28, 8, v84
v_and_b32 v30, 1, v30
v_lshl_add_u32 v84, v30, 7, v84
v_lshl_add_u32 v84, v31, 4, v84
v_add_u32 v84, 262144, v84
v_mov_b32 v95, s55
s_mov_b32 s84, 0xaaaaaaaa
s_mov_b32 s85, 0xaaaaaaaa
s_mov_b32 s86, 0xcccccccc
s_mov_b32 s87, 0xcccccccc
s_waitcnt lgkmcnt(0)
v_mfma_f32_16x16x32_bf16 v[208:211], a[0:3], v[20:23], 0
v_mfma_f32_16x16x32_bf16 v[212:215], a[4:7], v[20:23], 0
v_mfma_f32_16x16x32_bf16 v[216:219], a[8:11], v[20:23], 0
v_mfma_f32_16x16x32_bf16 v[220:223], a[12:15], v[20:23], 0
v_mfma_f32_16x16x32_bf16 v[224:227], a[16:19], v[20:23], 0
v_mfma_f32_16x16x32_bf16 v[228:231], a[20:23], v[20:23], 0
v_mfma_f32_16x16x32_bf16 v[232:235], a[24:27], v[20:23], 0
v_mfma_f32_16x16x32_bf16 v[236:239], a[28:31], v[20:23], 0
s_nop 0
v_mov_b32_dpp v12, v208 quad_perm:[0,1,2,3] row_mask:0xf bank_mask:0x1
v_mov_b32_dpp v13, v209 row_ror:12 row_mask:0xf bank_mask:0x1
v_mov_b32_dpp v14, v210 row_ror:8 row_mask:0xf bank_mask:0x1
v_mov_b32_dpp v15, v211 row_ror:4 row_mask:0xf bank_mask:0x1
v_mov_b32_dpp v12, v212 row_ror:4 row_mask:0xf bank_mask:0x2
v_mov_b32_dpp v13, v213 quad_perm:[0,1,2,3] row_mask:0xf bank_mask:0x2
v_mov_b32_dpp v14, v214 row_ror:12 row_mask:0xf bank_mask:0x2
v_mov_b32_dpp v15, v215 row_ror:8 row_mask:0xf bank_mask:0x2
v_mov_b32_dpp v12, v216 row_ror:8 row_mask:0xf bank_mask:0x4
v_mov_b32_dpp v13, v217 row_ror:4 row_mask:0xf bank_mask:0x4
v_mov_b32_dpp v14, v218 quad_perm:[0,1,2,3] row_mask:0xf bank_mask:0x4
v_mov_b32_dpp v15, v219 row_ror:12 row_mask:0xf bank_mask:0x4
v_mov_b32_dpp v12, v220 row_ror:12 row_mask:0xf bank_mask:0x8
v_mov_b32_dpp v13, v221 row_ror:8 row_mask:0xf bank_mask:0x8
v_mov_b32_dpp v14, v222 row_ror:4 row_mask:0xf bank_mask:0x8
v_mov_b32_dpp v15, v223 quad_perm:[0,1,2,3] row_mask:0xf bank_mask:0x8
v_add_f32 v12, v12, v13
v_add_f32 v14, v14, v15
v_add_f32 v248, v12, v14
v_cvt_pk_bf16_f32 v248, v248, v248
v_and_b32 v248, s6, v248
v_mul_f32 v248, s5, v248
v_cvt_pk_bf16_f32 v248, v248, v248
v_and_b32 v248, s6, v248
v_mfma_f32_16x16x32_bf16 v[208:211], a[32:35], v[20:23], 0
v_mfma_f32_16x16x32_bf16 v[212:215], a[36:39], v[20:23], 0
v_mfma_f32_16x16x32_bf16 v[216:219], a[40:43], v[20:23], 0
v_mfma_f32_16x16x32_bf16 v[220:223], a[44:47], v[20:23], 0
v_mov_b32_dpp v12, v224 quad_perm:[0,1,2,3] row_mask:0xf bank_mask:0x1
v_mov_b32_dpp v13, v225 row_ror:12 row_mask:0xf bank_mask:0x1
v_mov_b32_dpp v14, v226 row_ror:8 row_mask:0xf bank_mask:0x1
v_mov_b32_dpp v15, v227 row_ror:4 row_mask:0xf bank_mask:0x1
v_mov_b32_dpp v12, v228 row_ror:4 row_mask:0xf bank_mask:0x2
v_mov_b32_dpp v13, v229 quad_perm:[0,1,2,3] row_mask:0xf bank_mask:0x2
v_mov_b32_dpp v14, v230 row_ror:12 row_mask:0xf bank_mask:0x2
v_mov_b32_dpp v15, v231 row_ror:8 row_mask:0xf bank_mask:0x2
v_mov_b32_dpp v12, v232 row_ror:8 row_mask:0xf bank_mask:0x4
v_mov_b32_dpp v13, v233 row_ror:4 row_mask:0xf bank_mask:0x4
v_mov_b32_dpp v14, v234 quad_perm:[0,1,2,3] row_mask:0xf bank_mask:0x4
v_mov_b32_dpp v15, v235 row_ror:12 row_mask:0xf bank_mask:0x4
v_mov_b32_dpp v12, v236 row_ror:12 row_mask:0xf bank_mask:0x8
v_mov_b32_dpp v13, v237 row_ror:8 row_mask:0xf bank_mask:0x8
v_mov_b32_dpp v14, v238 row_ror:4 row_mask:0xf bank_mask:0x8
v_mov_b32_dpp v15, v239 quad_perm:[0,1,2,3] row_mask:0xf bank_mask:0x8
v_add_f32 v12, v12, v13
v_add_f32 v14, v14, v15
v_add_f32 v249, v12, v14
v_cvt_pk_bf16_f32 v249, v249, v249
v_and_b32 v249, s6, v249
v_mul_f32 v249, s5, v249
v_cvt_pk_bf16_f32 v249, v249, v249
v_and_b32 v249, s6, v249
v_mfma_f32_16x16x32_bf16 v[224:227], a[48:51], v[20:23], 0
v_mfma_f32_16x16x32_bf16 v[228:231], a[52:55], v[20:23], 0
v_mfma_f32_16x16x32_bf16 v[232:235], a[56:59], v[20:23], 0
v_mfma_f32_16x16x32_bf16 v[236:239], a[60:63], v[20:23], 0
v_mov_b32_dpp v12, v208 quad_perm:[0,1,2,3] row_mask:0xf bank_mask:0x1
v_mov_b32_dpp v13, v209 row_ror:12 row_mask:0xf bank_mask:0x1
v_mov_b32_dpp v14, v210 row_ror:8 row_mask:0xf bank_mask:0x1
v_mov_b32_dpp v15, v211 row_ror:4 row_mask:0xf bank_mask:0x1
v_mov_b32_dpp v12, v212 row_ror:4 row_mask:0xf bank_mask:0x2
v_mov_b32_dpp v13, v213 quad_perm:[0,1,2,3] row_mask:0xf bank_mask:0x2
v_mov_b32_dpp v14, v214 row_ror:12 row_mask:0xf bank_mask:0x2
v_mov_b32_dpp v15, v215 row_ror:8 row_mask:0xf bank_mask:0x2
v_mov_b32_dpp v12, v216 row_ror:8 row_mask:0xf bank_mask:0x4
v_mov_b32_dpp v13, v217 row_ror:4 row_mask:0xf bank_mask:0x4
v_mov_b32_dpp v14, v218 quad_perm:[0,1,2,3] row_mask:0xf bank_mask:0x4
v_mov_b32_dpp v15, v219 row_ror:12 row_mask:0xf bank_mask:0x4
v_mov_b32_dpp v12, v220 row_ror:12 row_mask:0xf bank_mask:0x8
v_mov_b32_dpp v13, v221 row_ror:8 row_mask:0xf bank_mask:0x8
v_mov_b32_dpp v14, v222 row_ror:4 row_mask:0xf bank_mask:0x8
v_mov_b32_dpp v15, v223 quad_perm:[0,1,2,3] row_mask:0xf bank_mask:0x8
v_add_f32 v12, v12, v13
v_add_f32 v14, v14, v15
v_add_f32 v250, v12, v14
v_cvt_pk_bf16_f32 v250, v250, v250
v_and_b32 v250, s6, v250
v_mul_f32 v250, s5, v250
v_cvt_pk_bf16_f32 v250, v250, v250
v_and_b32 v250, s6, v250
v_mov_b32_dpp v12, v224 quad_perm:[0,1,2,3] row_mask:0xf bank_mask:0x1
v_mov_b32_dpp v13, v225 row_ror:12 row_mask:0xf bank_mask:0x1
v_mov_b32_dpp v14, v226 row_ror:8 row_mask:0xf bank_mask:0x1
v_mov_b32_dpp v15, v227 row_ror:4 row_mask:0xf bank_mask:0x1
v_mov_b32_dpp v12, v228 row_ror:4 row_mask:0xf bank_mask:0x2
v_mov_b32_dpp v13, v229 quad_perm:[0,1,2,3] row_mask:0xf bank_mask:0x2
v_mov_b32_dpp v14, v230 row_ror:12 row_mask:0xf bank_mask:0x2
v_mov_b32_dpp v15, v231 row_ror:8 row_mask:0xf bank_mask:0x2
v_mov_b32_dpp v12, v232 row_ror:8 row_mask:0xf bank_mask:0x4
v_mov_b32_dpp v13, v233 row_ror:4 row_mask:0xf bank_mask:0x4
v_mov_b32_dpp v14, v234 quad_perm:[0,1,2,3] row_mask:0xf bank_mask:0x4
v_mov_b32_dpp v15, v235 row_ror:12 row_mask:0xf bank_mask:0x4
v_mov_b32_dpp v12, v236 row_ror:12 row_mask:0xf bank_mask:0x8
v_mov_b32_dpp v13, v237 row_ror:8 row_mask:0xf bank_mask:0x8
v_mov_b32_dpp v14, v238 row_ror:4 row_mask:0xf bank_mask:0x8
v_mov_b32_dpp v15, v239 quad_perm:[0,1,2,3] row_mask:0xf bank_mask:0x8
v_add_f32 v12, v12, v13
v_add_f32 v14, v14, v15
v_add_f32 v251, v12, v14
v_cvt_pk_bf16_f32 v251, v251, v251
v_and_b32 v251, s6, v251
v_mul_f32 v251, s5, v251
v_cvt_pk_bf16_f32 v251, v251, v251
v_and_b32 v251, s6, v251
v_max3_f32 v252, v248, v249, v250
v_max_f32 v252, v252, v251
s_nop 1
v_max_f32_dpp v252, v252, v252 row_ror:4 row_mask:0xf bank_mask:0xf
s_nop 1
v_max_f32_dpp v252, v252, v252 row_ror:8 row_mask:0xf bank_mask:0xf
v_mov_b32 v28, v252
s_nop 1
v_permlane16_swap_b32 v252, v28
v_max_f32 v252, v252, v28
v_mov_b32 v28, v252
s_nop 1
v_permlane32_swap_b32 v252, v28
v_max_f32 v252, v252, v28
v_mul_f32 v253, s4, v252
v_fma_f32 v248, v248, s4, -v253
v_fma_f32 v249, v249, s4, -v253
v_fma_f32 v250, v250, s4, -v253
v_fma_f32 v251, v251, s4, -v253
v_exp_f32 v248, v248
v_exp_f32 v249, v249
v_exp_f32 v250, v250
v_exp_f32 v251, v251
v_add_f32 v254, v248, v249
v_add_f32 v28, v250, v251
v_add_f32 v254, v254, v28
v_mov_b32_dpp v29, v248 row_shl:4 row_mask:0xf bank_mask:0xf bound_ctrl:0
v_mov_b32_dpp v30, v248 row_shl:8 row_mask:0xf bank_mask:0xf bound_ctrl:0
v_mov_b32_dpp v31, v248 row_shl:12 row_mask:0xf bank_mask:0xf bound_ctrl:0
v_cvt_pk_bf16_f32 v16, v248, v29
v_cvt_pk_bf16_f32 v17, v30, v31
v_mov_b32_dpp v29, v249 row_shl:4 row_mask:0xf bank_mask:0xf bound_ctrl:0
v_mov_b32_dpp v30, v249 row_shl:8 row_mask:0xf bank_mask:0xf bound_ctrl:0
v_mov_b32_dpp v31, v249 row_shl:12 row_mask:0xf bank_mask:0xf bound_ctrl:0
v_cvt_pk_bf16_f32 v18, v249, v29
v_cvt_pk_bf16_f32 v19, v30, v31
s_cmp_ge_u32 s2, 128
s_cbranch_scc1 L_wl_8
s_waitcnt vmcnt(16)
s_branch L_wh_9
L_wl_8:
s_waitcnt vmcnt(32)
L_wh_9:
v_perm_b32 v224, v100, v96, s62
v_perm_b32 v225, v108, v104, s62
v_perm_b32 v226, v116, v112, s62
v_perm_b32 v227, v124, v120, s62
v_perm_b32 v228, v100, v96, s63
v_perm_b32 v229, v108, v104, s63
v_perm_b32 v230, v116, v112, s63
v_perm_b32 v231, v124, v120, s63
v_mfma_f32_16x16x32_bf16 a[100:103], v[224:227], v[16:19], 0
v_perm_b32 v232, v101, v97, s62
v_perm_b32 v233, v109, v105, s62
v_perm_b32 v234, v117, v113, s62
v_perm_b32 v235, v125, v121, s62
v_mfma_f32_16x16x32_bf16 a[104:107], v[228:231], v[16:19], 0
v_perm_b32 v236, v101, v97, s63
v_perm_b32 v237, v109, v105, s63
v_perm_b32 v238, v117, v113, s63
v_perm_b32 v239, v125, v121, s63
v_mfma_f32_16x16x32_bf16 a[108:111], v[232:235], v[16:19], 0
v_perm_b32 v224, v102, v98, s62
v_perm_b32 v225, v110, v106, s62
v_perm_b32 v226, v118, v114, s62
v_perm_b32 v227, v126, v122, s62
v_mfma_f32_16x16x32_bf16 a[112:115], v[236:239], v[16:19], 0
v_perm_b32 v228, v102, v98, s63
v_perm_b32 v229, v110, v106, s63
v_perm_b32 v230, v118, v114, s63
v_perm_b32 v231, v126, v122, s63
v_mfma_f32_16x16x32_bf16 a[116:119], v[224:227], v[16:19], 0
v_perm_b32 v232, v103, v99, s62
v_perm_b32 v233, v111, v107, s62
v_perm_b32 v234, v119, v115, s62
v_perm_b32 v235, v127, v123, s62
v_mfma_f32_16x16x32_bf16 a[120:123], v[228:231], v[16:19], 0
v_perm_b32 v236, v103, v99, s63
v_perm_b32 v237, v111, v107, s63
v_perm_b32 v238, v119, v115, s63
v_perm_b32 v239, v127, v123, s63
v_mfma_f32_16x16x32_bf16 a[124:127], v[232:235], v[16:19], 0
s_nop 0
v_mfma_f32_16x16x32_bf16 a[128:131], v[236:239], v[16:19], 0
v_mov_b32_dpp v29, v250 row_shl:4 row_mask:0xf bank_mask:0xf bound_ctrl:0
v_mov_b32_dpp v30, v250 row_shl:8 row_mask:0xf bank_mask:0xf bound_ctrl:0
v_mov_b32_dpp v31, v250 row_shl:12 row_mask:0xf bank_mask:0xf bound_ctrl:0
v_cvt_pk_bf16_f32 v16, v250, v29
v_cvt_pk_bf16_f32 v17, v30, v31
v_mov_b32_dpp v29, v251 row_shl:4 row_mask:0xf bank_mask:0xf bound_ctrl:0
v_mov_b32_dpp v30, v251 row_shl:8 row_mask:0xf bank_mask:0xf bound_ctrl:0
v_mov_b32_dpp v31, v251 row_shl:12 row_mask:0xf bank_mask:0xf bound_ctrl:0
v_cvt_pk_bf16_f32 v18, v251, v29
v_cvt_pk_bf16_f32 v19, v30, v31
s_cmp_ge_u32 s2, 128
s_cbranch_scc1 L_wl_10
s_waitcnt vmcnt(8)
s_branch L_wh_11
L_wl_10:
s_waitcnt vmcnt(24)
L_wh_11:
v_perm_b32 v224, v132, v128, s62
v_perm_b32 v225, v140, v136, s62
v_perm_b32 v226, v148, v144, s62
v_perm_b32 v227, v156, v152, s62
v_perm_b32 v228, v132, v128, s63
v_perm_b32 v229, v140, v136, s63
v_perm_b32 v230, v148, v144, s63
v_perm_b32 v231, v156, v152, s63
v_mfma_f32_16x16x32_bf16 a[100:103], v[224:227], v[16:19], a[100:103]
v_perm_b32 v232, v133, v129, s62
v_perm_b32 v233, v141, v137, s62
v_perm_b32 v234, v149, v145, s62
v_perm_b32 v235, v157, v153, s62
v_mfma_f32_16x16x32_bf16 a[104:107], v[228:231], v[16:19], a[104:107]
v_perm_b32 v236, v133, v129, s63
v_perm_b32 v237, v141, v137, s63
v_perm_b32 v238, v149, v145, s63
v_perm_b32 v239, v157, v153, s63
v_mfma_f32_16x16x32_bf16 a[108:111], v[232:235], v[16:19], a[108:111]
v_perm_b32 v224, v134, v130, s62
v_perm_b32 v225, v142, v138, s62
v_perm_b32 v226, v150, v146, s62
v_perm_b32 v227, v158, v154, s62
v_mfma_f32_16x16x32_bf16 a[112:115], v[236:239], v[16:19], a[112:115]
v_perm_b32 v228, v134, v130, s63
v_perm_b32 v229, v142, v138, s63
v_perm_b32 v230, v150, v146, s63
v_perm_b32 v231, v158, v154, s63
v_mfma_f32_16x16x32_bf16 a[116:119], v[224:227], v[16:19], a[116:119]
v_perm_b32 v232, v135, v131, s62
v_perm_b32 v233, v143, v139, s62
v_perm_b32 v234, v151, v147, s62
v_perm_b32 v235, v159, v155, s62
v_mfma_f32_16x16x32_bf16 a[120:123], v[228:231], v[16:19], a[120:123]
v_perm_b32 v236, v135, v131, s63
v_perm_b32 v237, v143, v139, s63
v_perm_b32 v238, v151, v147, s63
v_perm_b32 v239, v159, v155, s63
v_mfma_f32_16x16x32_bf16 a[124:127], v[232:235], v[16:19], a[124:127]
s_nop 0
v_mfma_f32_16x16x32_bf16 a[128:131], v[236:239], v[16:19], a[128:131]
v_add_f32_dpp v254, v254, v254 row_ror:4 row_mask:0xf bank_mask:0xf
s_nop 1
v_add_f32_dpp v254, v254, v254 row_ror:8 row_mask:0xf bank_mask:0xf
v_mov_b32 v240, v254
s_nop 1
v_permlane16_swap_b32 v254, v240
v_add_f32 v254, v254, v240
v_mov_b32 v240, v254
s_nop 1
v_permlane32_swap_b32 v254, v240
v_add_f32 v254, v254, v240
s_mov_b32 exec_lo, 0xf000f
s_mov_b32 exec_hi, 0xf000f
ds_write_b128 v80, a[100:103] offset:10240
ds_write_b128 v80, a[104:107] offset:10256
ds_write_b128 v80, a[108:111] offset:10272
ds_write_b128 v80, a[112:115] offset:10288
ds_write_b128 v80, a[116:119] offset:10304
ds_write_b128 v80, a[120:123] offset:10320
ds_write_b128 v80, a[124:127] offset:10336
ds_write_b128 v80, a[128:131] offset:10352
s_mov_b64 exec, 0xf
ds_write_b32 v81, v252 offset:27136
ds_write_b32 v81, v254 offset:27152
s_mov_b64 exec, -1
s_cmp_lt_u32 s2, 128
s_cbranch_scc1 L_nowot
s_waitcnt vmcnt(8)
v_accvgpr_read_b32 v160, a132
v_accvgpr_read_b32 v161, a133
v_accvgpr_read_b32 v162, a134
v_accvgpr_read_b32 v163, a135
v_accvgpr_read_b32 v164, a136
v_accvgpr_read_b32 v165, a137
v_accvgpr_read_b32 v166, a138
v_accvgpr_read_b32 v167, a139
v_accvgpr_read_b32 v168, a140
v_accvgpr_read_b32 v169, a141
v_accvgpr_read_b32 v170, a142
v_accvgpr_read_b32 v171, a143
v_accvgpr_read_b32 v172, a144
v_accvgpr_read_b32 v173, a145
v_accvgpr_read_b32 v174, a146
v_accvgpr_read_b32 v175, a147
v_accvgpr_read_b32 v176, a148
v_accvgpr_read_b32 v177, a149
v_accvgpr_read_b32 v178, a150
v_accvgpr_read_b32 v179, a151
v_accvgpr_read_b32 v180, a152
v_accvgpr_read_b32 v181, a153
v_accvgpr_read_b32 v182, a154
v_accvgpr_read_b32 v183, a155
v_accvgpr_read_b32 v184, a156
v_accvgpr_read_b32 v185, a157
v_accvgpr_read_b32 v186, a158
v_accvgpr_read_b32 v187, a159
v_accvgpr_read_b32 v188, a160
v_accvgpr_read_b32 v189, a161
v_accvgpr_read_b32 v190, a162
v_accvgpr_read_b32 v191, a163
v_perm_b32 v96, v164, v160, s62
v_perm_b32 v97, v172, v168, s62
v_perm_b32 v98, v180, v176, s62
v_perm_b32 v99, v188, v184, s62
v_perm_b32 v100, v164, v160, s63
v_perm_b32 v101, v172, v168, s63
v_perm_b32 v102, v180, v176, s63
v_perm_b32 v103, v188, v184, s63
v_perm_b32 v104, v165, v161, s62
v_perm_b32 v105, v173, v169, s62
v_perm_b32 v106, v181, v177, s62
v_perm_b32 v107, v189, v185, s62
v_perm_b32 v108, v165, v161, s63
v_perm_b32 v109, v173, v169, s63
v_perm_b32 v110, v181, v177, s63
v_perm_b32 v111, v189, v185, s63
v_perm_b32 v112, v166, v162, s62
v_perm_b32 v113, v174, v170, s62
v_perm_b32 v114, v182, v178, s62
v_perm_b32 v115, v190, v186, s62
v_perm_b32 v116, v166, v162, s63
v_perm_b32 v117, v174, v170, s63
v_perm_b32 v118, v182, v178, s63
v_perm_b32 v119, v190, v186, s63
v_perm_b32 v120, v167, v163, s62
v_perm_b32 v121, v175, v171, s62
v_perm_b32 v122, v183, v179, s62
v_perm_b32 v123, v191, v187, s62
v_perm_b32 v124, v167, v163, s63
v_perm_b32 v125, v175, v171, s63
v_perm_b32 v126, v183, v179, s63
v_perm_b32 v127, v191, v187, s63
v_accvgpr_read_b32 v160, a164
v_accvgpr_read_b32 v161, a165
v_accvgpr_read_b32 v162, a166
v_accvgpr_read_b32 v163, a167
v_accvgpr_read_b32 v164, a168
v_accvgpr_read_b32 v165, a169
v_accvgpr_read_b32 v166, a170
v_accvgpr_read_b32 v167, a171
v_accvgpr_read_b32 v168, a172
v_accvgpr_read_b32 v169, a173
v_accvgpr_read_b32 v170, a174
v_accvgpr_read_b32 v171, a175
v_accvgpr_read_b32 v172, a176
v_accvgpr_read_b32 v173, a177
v_accvgpr_read_b32 v174, a178
v_accvgpr_read_b32 v175, a179
v_accvgpr_read_b32 v176, a180
v_accvgpr_read_b32 v177, a181
v_accvgpr_read_b32 v178, a182
v_accvgpr_read_b32 v179, a183
v_accvgpr_read_b32 v180, a184
v_accvgpr_read_b32 v181, a185
v_accvgpr_read_b32 v182, a186
v_accvgpr_read_b32 v183, a187
v_accvgpr_read_b32 v184, a188
v_accvgpr_read_b32 v185, a189
v_accvgpr_read_b32 v186, a190
v_accvgpr_read_b32 v187, a191
v_accvgpr_read_b32 v188, a192
v_accvgpr_read_b32 v189, a193
v_accvgpr_read_b32 v190, a194
v_accvgpr_read_b32 v191, a195
v_perm_b32 v128, v164, v160, s62
v_perm_b32 v129, v172, v168, s62
v_perm_b32 v130, v180, v176, s62
v_perm_b32 v131, v188, v184, s62
v_perm_b32 v132, v164, v160, s63
v_perm_b32 v133, v172, v168, s63
v_perm_b32 v134, v180, v176, s63
v_perm_b32 v135, v188, v184, s63
v_perm_b32 v136, v165, v161, s62
v_perm_b32 v137, v173, v169, s62
v_perm_b32 v138, v181, v177, s62
v_perm_b32 v139, v189, v185, s62
v_perm_b32 v140, v165, v161, s63
v_perm_b32 v141, v173, v169, s63
v_perm_b32 v142, v181, v177, s63
v_perm_b32 v143, v189, v185, s63
v_perm_b32 v144, v166, v162, s62
v_perm_b32 v145, v174, v170, s62
v_perm_b32 v146, v182, v178, s62
v_perm_b32 v147, v190, v186, s62
v_perm_b32 v148, v166, v162, s63
v_perm_b32 v149, v174, v170, s63
v_perm_b32 v150, v182, v178, s63
v_perm_b32 v151, v190, v186, s63
v_perm_b32 v152, v167, v163, s62
v_perm_b32 v153, v175, v171, s62
v_perm_b32 v154, v183, v179, s62
v_perm_b32 v155, v191, v187, s62
v_perm_b32 v156, v167, v163, s63
v_perm_b32 v157, v175, v171, s63
v_perm_b32 v158, v183, v179, s63
v_perm_b32 v159, v191, v187, s63
L_nowot:
s_mov_b32 s99, 1
L_loop_0:
s_waitcnt vmcnt(4)
v_mfma_f32_16x16x32_bf16 v[208:211], a[64:67], v[24:27], 0
v_mfma_f32_16x16x32_bf16 v[212:215], a[68:71], v[24:27], 0
v_mfma_f32_16x16x32_bf16 v[216:219], a[72:75], v[24:27], 0
v_mfma_f32_16x16x32_bf16 v[220:223], a[76:79], v[24:27], 0
v_readfirstlane_b32 s60, v6
s_mov_b32 s59, 1
s_cmp_ge_u32 s60, 512
s_cbranch_scc1 L_lastprep_0
s_mul_i32 s58, s49, 8
s_add_u32 s58, s58, s60
s_and_b32 s58, s58, 511
s_lshl_b32 s58, s58, 12
s_add_u32 s58, s58, s57
buffer_load_dwordx4 a[64:67], v2, s[16:19], s58 offen offset:0 nt
buffer_load_dwordx4 a[68:71], v2, s[16:19], s58 offen offset:1024 nt
buffer_load_dwordx4 a[72:75], v2, s[16:19], s58 offen offset:2048 nt
buffer_load_dwordx4 a[76:79], v2, s[16:19], s58 offen offset:3072 nt
s_add_u32 s99, s99, 1
s_cmp_lt_u32 s99, 10
s_cbranch_scc1 L_static_0
s_cmp_lt_u32 s60, 488
s_cbranch_scc1 L_take_0
s_lshl_b32 s92, s99, 5
s_add_u32 s92, s92, 64
s_cmp_gt_u32 s92, s60
s_cbranch_scc1 L_take_0
s_mov_b32 s59, 2
v_mov_b32 v6, 512
s_branch L_vnext_0
L_take_0:
s_mov_b32 s59, 0
s_mov_b64 exec, 1
global_atomic_add v6, v5, v4, s[90:91] sc0 sc1
s_mov_b64 exec, -1
s_branch L_vnext_0
L_static_0:
s_mov_b32 s59, 2
v_add_u32 v6, 32, v6
L_vnext_0:
buffer_load_dwordx4 v[64:67], v3, s[20:23], s58 offen offset:0 nt
buffer_load_dwordx4 v[68:71], v3, s[20:23], s58 offen offset:1024 nt
buffer_load_dwordx4 v[72:75], v3, s[20:23], s58 offen offset:2048 nt
buffer_load_dwordx4 v[76:79], v3, s[20:23], s58 offen offset:3072 nt
L_nonext_0:
v_mov_b32_dpp v12, v208 quad_perm:[0,1,2,3] row_mask:0xf bank_mask:0x1
v_mov_b32_dpp v13, v209 row_ror:12 row_mask:0xf bank_mask:0x1
v_mov_b32_dpp v14, v210 row_ror:8 row_mask:0xf bank_mask:0x1
v_mov_b32_dpp v15, v211 row_ror:4 row_mask:0xf bank_mask:0x1
v_mov_b32_dpp v12, v212 row_ror:4 row_mask:0xf bank_mask:0x2
v_mov_b32_dpp v13, v213 quad_perm:[0,1,2,3] row_mask:0xf bank_mask:0x2
v_mov_b32_dpp v14, v214 row_ror:12 row_mask:0xf bank_mask:0x2
v_mov_b32_dpp v15, v215 row_ror:8 row_mask:0xf bank_mask:0x2
v_mov_b32_dpp v12, v216 row_ror:8 row_mask:0xf bank_mask:0x4
v_mov_b32_dpp v13, v217 row_ror:4 row_mask:0xf bank_mask:0x4
v_mov_b32_dpp v14, v218 quad_perm:[0,1,2,3] row_mask:0xf bank_mask:0x4
v_mov_b32_dpp v15, v219 row_ror:12 row_mask:0xf bank_mask:0x4
v_mov_b32_dpp v12, v220 row_ror:12 row_mask:0xf bank_mask:0x8
v_mov_b32_dpp v13, v221 row_ror:8 row_mask:0xf bank_mask:0x8
v_mov_b32_dpp v14, v222 row_ror:4 row_mask:0xf bank_mask:0x8
v_mov_b32_dpp v15, v223 quad_perm:[0,1,2,3] row_mask:0xf bank_mask:0x8
v_add_f32 v12, v12, v13
v_add_f32 v14, v14, v15
v_add_f32 v10, v12, v14
v_cvt_pk_bf16_f32 v10, v10, v10
v_and_b32 v10, s6, v10
v_mul_f32 v10, s5, v10
v_cvt_pk_bf16_f32 v10, v10, v10
v_and_b32 v10, s6, v10
v_cmp_gt_f32 vcc, v10, v7
s_nop 0
s_cbranch_vccnz L_slow_0
L_fast_0:
v_fma_f32 v11, v10, s4, -v8
v_exp_f32 v11, v11
s_nop 0
v_add_f32 v9, v9, v11
v_mov_b32_dpp v29, v11 row_shl:4 row_mask:0xf bank_mask:0xf bound_ctrl:0
v_mov_b32_dpp v30, v11 row_shl:8 row_mask:0xf bank_mask:0xf bound_ctrl:0
v_mov_b32_dpp v31, v11 row_shl:12 row_mask:0xf bank_mask:0xf bound_ctrl:0
v_cvt_pk_bf16_f32 v16, v11, v29
v_cvt_pk_bf16_f32 v17, v30, v31
s_cmp_eq_u32 s59, 0
s_cbranch_scc1 L_wv5_0
s_cmp_eq_u32 s59, 1
s_cbranch_scc1 L_wv0_0
s_waitcnt vmcnt(8)
s_branch L_pv_0
L_wv0_0:
s_cmp_ge_u32 s2, 128
s_cbranch_scc1 L_wl_12
s_waitcnt vmcnt(0)
s_branch L_wh_13
L_wl_12:
s_waitcnt vmcnt(4)
L_wh_13:
s_branch L_pv_0
L_wv5_0:
s_waitcnt vmcnt(9)
L_pv_0:
v_perm_b32 v224, v196, v192, s62
v_perm_b32 v225, v204, v200, s62
v_perm_b32 v226, v196, v192, s63
v_perm_b32 v227, v204, v200, s63
v_perm_b32 v228, v197, v193, s62
v_perm_b32 v229, v205, v201, s62
v_perm_b32 v230, v197, v193, s63
v_perm_b32 v231, v205, v201, s63
v_perm_b32 v232, v198, v194, s62
v_perm_b32 v233, v206, v202, s62
v_perm_b32 v234, v198, v194, s63
v_perm_b32 v235, v206, v202, s63
v_perm_b32 v236, v199, v195, s62
v_perm_b32 v237, v207, v203, s62
v_perm_b32 v238, v199, v195, s63
v_perm_b32 v239, v207, v203, s63
v_mfma_f32_16x16x16_bf16 v[32:35], v[224:225], v[16:17], v[32:35]
v_mfma_f32_16x16x16_bf16 v[36:39], v[226:227], v[16:17], v[36:39]
v_mfma_f32_16x16x16_bf16 v[40:43], v[228:229], v[16:17], v[40:43]
v_mfma_f32_16x16x16_bf16 v[44:47], v[230:231], v[16:17], v[44:47]
v_mfma_f32_16x16x16_bf16 v[48:51], v[232:233], v[16:17], v[48:51]
v_mfma_f32_16x16x16_bf16 v[52:55], v[234:235], v[16:17], v[52:55]
v_mfma_f32_16x16x16_bf16 v[56:59], v[236:237], v[16:17], v[56:59]
v_mfma_f32_16x16x16_bf16 v[60:63], v[238:239], v[16:17], v[60:63]
s_cmp_eq_u32 s59, 1
s_cbranch_scc1 L_bdone
L_loop_1:
s_waitcnt vmcnt(4)
v_mfma_f32_16x16x32_bf16 v[208:211], a[64:67], v[24:27], 0
v_mfma_f32_16x16x32_bf16 v[212:215], a[68:71], v[24:27], 0
v_mfma_f32_16x16x32_bf16 v[216:219], a[72:75], v[24:27], 0
v_mfma_f32_16x16x32_bf16 v[220:223], a[76:79], v[24:27], 0
v_readfirstlane_b32 s60, v6
s_mov_b32 s59, 1
s_cmp_ge_u32 s60, 512
s_cbranch_scc1 L_lastprep_1
s_mul_i32 s58, s49, 8
s_add_u32 s58, s58, s60
s_and_b32 s58, s58, 511
s_lshl_b32 s58, s58, 12
s_add_u32 s58, s58, s57
buffer_load_dwordx4 a[64:67], v2, s[16:19], s58 offen offset:0 nt
buffer_load_dwordx4 a[68:71], v2, s[16:19], s58 offen offset:1024 nt
buffer_load_dwordx4 a[72:75], v2, s[16:19], s58 offen offset:2048 nt
buffer_load_dwordx4 a[76:79], v2, s[16:19], s58 offen offset:3072 nt
s_add_u32 s99, s99, 1
s_cmp_lt_u32 s99, 10
s_cbranch_scc1 L_static_1
s_cmp_lt_u32 s60, 488
s_cbranch_scc1 L_take_1
s_lshl_b32 s92, s99, 5
s_add_u32 s92, s92, 64
s_cmp_gt_u32 s92, s60
s_cbranch_scc1 L_take_1
s_mov_b32 s59, 2
v_mov_b32 v6, 512
s_branch L_vnext_1
L_take_1:
s_mov_b32 s59, 0
s_mov_b64 exec, 1
global_atomic_add v6, v5, v4, s[90:91] sc0 sc1
s_mov_b64 exec, -1
s_branch L_vnext_1
L_static_1:
s_mov_b32 s59, 2
v_add_u32 v6, 32, v6
L_vnext_1:
buffer_load_dwordx4 v[192:195], v3, s[20:23], s58 offen offset:0 nt
buffer_load_dwordx4 v[196:199], v3, s[20:23], s58 offen offset:1024 nt
buffer_load_dwordx4 v[200:203], v3, s[20:23], s58 offen offset:2048 nt
buffer_load_dwordx4 v[204:207], v3, s[20:23], s58 offen offset:3072 nt
L_nonext_1:
v_mov_b32_dpp v12, v208 quad_perm:[0,1,2,3] row_mask:0xf bank_mask:0x1
v_mov_b32_dpp v13, v209 row_ror:12 row_mask:0xf bank_mask:0x1
v_mov_b32_dpp v14, v210 row_ror:8 row_mask:0xf bank_mask:0x1
v_mov_b32_dpp v15, v211 row_ror:4 row_mask:0xf bank_mask:0x1
v_mov_b32_dpp v12, v212 row_ror:4 row_mask:0xf bank_mask:0x2
v_mov_b32_dpp v13, v213 quad_perm:[0,1,2,3] row_mask:0xf bank_mask:0x2
v_mov_b32_dpp v14, v214 row_ror:12 row_mask:0xf bank_mask:0x2
v_mov_b32_dpp v15, v215 row_ror:8 row_mask:0xf bank_mask:0x2
v_mov_b32_dpp v12, v216 row_ror:8 row_mask:0xf bank_mask:0x4
v_mov_b32_dpp v13, v217 row_ror:4 row_mask:0xf bank_mask:0x4
v_mov_b32_dpp v14, v218 quad_perm:[0,1,2,3] row_mask:0xf bank_mask:0x4
v_mov_b32_dpp v15, v219 row_ror:12 row_mask:0xf bank_mask:0x4
v_mov_b32_dpp v12, v220 row_ror:12 row_mask:0xf bank_mask:0x8
v_mov_b32_dpp v13, v221 row_ror:8 row_mask:0xf bank_mask:0x8
v_mov_b32_dpp v14, v222 row_ror:4 row_mask:0xf bank_mask:0x8
v_mov_b32_dpp v15, v223 quad_perm:[0,1,2,3] row_mask:0xf bank_mask:0x8
v_add_f32 v12, v12, v13
v_add_f32 v14, v14, v15
v_add_f32 v10, v12, v14
v_cvt_pk_bf16_f32 v10, v10, v10
v_and_b32 v10, s6, v10
v_mul_f32 v10, s5, v10
v_cvt_pk_bf16_f32 v10, v10, v10
v_and_b32 v10, s6, v10
v_cmp_gt_f32 vcc, v10, v7
s_nop 0
s_cbranch_vccnz L_slow_1
L_fast_1:
v_fma_f32 v11, v10, s4, -v8
v_exp_f32 v11, v11
s_nop 0
v_add_f32 v9, v9, v11
v_mov_b32_dpp v29, v11 row_shl:4 row_mask:0xf bank_mask:0xf bound_ctrl:0
v_mov_b32_dpp v30, v11 row_shl:8 row_mask:0xf bank_mask:0xf bound_ctrl:0
v_mov_b32_dpp v31, v11 row_shl:12 row_mask:0xf bank_mask:0xf bound_ctrl:0
v_cvt_pk_bf16_f32 v16, v11, v29
v_cvt_pk_bf16_f32 v17, v30, v31
s_cmp_eq_u32 s59, 0
s_cbranch_scc1 L_wv5_1
s_cmp_eq_u32 s59, 1
s_cbranch_scc1 L_wv0_1
s_waitcnt vmcnt(8)
s_branch L_pv_1
L_wv0_1:
s_cmp_ge_u32 s2, 128
s_cbranch_scc1 L_wl_14
s_waitcnt vmcnt(0)
s_branch L_wh_15
L_wl_14:
s_waitcnt vmcnt(4)
L_wh_15:
s_branch L_pv_1
L_wv5_1:
s_waitcnt vmcnt(9)
L_pv_1:
v_perm_b32 v224, v68, v64, s62
v_perm_b32 v225, v76, v72, s62
v_perm_b32 v226, v68, v64, s63
v_perm_b32 v227, v76, v72, s63
v_perm_b32 v228, v69, v65, s62
v_perm_b32 v229, v77, v73, s62
v_perm_b32 v230, v69, v65, s63
v_perm_b32 v231, v77, v73, s63
v_perm_b32 v232, v70, v66, s62
v_perm_b32 v233, v78, v74, s62
v_perm_b32 v234, v70, v66, s63
v_perm_b32 v235, v78, v74, s63
v_perm_b32 v236, v71, v67, s62
v_perm_b32 v237, v79, v75, s62
v_perm_b32 v238, v71, v67, s63
v_perm_b32 v239, v79, v75, s63
v_mfma_f32_16x16x16_bf16 v[32:35], v[224:225], v[16:17], v[32:35]
v_mfma_f32_16x16x16_bf16 v[36:39], v[226:227], v[16:17], v[36:39]
v_mfma_f32_16x16x16_bf16 v[40:43], v[228:229], v[16:17], v[40:43]
v_mfma_f32_16x16x16_bf16 v[44:47], v[230:231], v[16:17], v[44:47]
v_mfma_f32_16x16x16_bf16 v[48:51], v[232:233], v[16:17], v[48:51]
v_mfma_f32_16x16x16_bf16 v[52:55], v[234:235], v[16:17], v[52:55]
v_mfma_f32_16x16x16_bf16 v[56:59], v[236:237], v[16:17], v[56:59]
v_mfma_f32_16x16x16_bf16 v[60:63], v[238:239], v[16:17], v[60:63]
s_cmp_eq_u32 s59, 1
s_cbranch_scc1 L_bdone
s_branch L_loop_0
L_lastprep_0:
s_cmp_lt_u32 s2, 128
s_cbranch_scc1 L_nonext_0
buffer_load_dwordx4 v[160:163], v86, s[36:39], s24 offen offset:0 sc1
buffer_load_dwordx4 v[164:167], v244, s[36:39], s24 offen offset:0 sc1
buffer_load_dwordx4 v[168:171], v87, s[36:39], s25 offen offset:0 sc1
buffer_load_dwordx4 v[172:175], v245, s[36:39], s25 offen offset:0 sc1
s_branch L_nonext_0
L_slow_0:
v_mov_b32 v11, v10
s_nop 1
v_max_f32_dpp v11, v11, v11 row_ror:4 row_mask:0xf bank_mask:0xf
s_nop 1
v_max_f32_dpp v11, v11, v11 row_ror:8 row_mask:0xf bank_mask:0xf
v_mov_b32 v28, v11
s_nop 1
v_permlane16_swap_b32 v11, v28
v_max_f32 v11, v11, v28
v_mov_b32 v28, v11
s_nop 1
v_permlane32_swap_b32 v11, v28
v_max_f32 v11, v11, v28
v_max_f32 v11, v11, v7
v_sub_f32 v28, v7, v11
v_mul_f32 v28, s4, v28
v_exp_f32 v28, v28
v_mov_b32 v7, v11
v_mul_f32 v8, s4, v11
v_mul_f32 v9, v9, v28
v_mul_f32 v32, v32, v28
v_mul_f32 v33, v33, v28
v_mul_f32 v34, v34, v28
v_mul_f32 v35, v35, v28
v_mul_f32 v36, v36, v28
v_mul_f32 v37, v37, v28
v_mul_f32 v38, v38, v28
v_mul_f32 v39, v39, v28
v_mul_f32 v40, v40, v28
v_mul_f32 v41, v41, v28
v_mul_f32 v42, v42, v28
v_mul_f32 v43, v43, v28
v_mul_f32 v44, v44, v28
v_mul_f32 v45, v45, v28
v_mul_f32 v46, v46, v28
v_mul_f32 v47, v47, v28
v_mul_f32 v48, v48, v28
v_mul_f32 v49, v49, v28
v_mul_f32 v50, v50, v28
v_mul_f32 v51, v51, v28
v_mul_f32 v52, v52, v28
v_mul_f32 v53, v53, v28
v_mul_f32 v54, v54, v28
v_mul_f32 v55, v55, v28
v_mul_f32 v56, v56, v28
v_mul_f32 v57, v57, v28
v_mul_f32 v58, v58, v28
v_mul_f32 v59, v59, v28
v_mul_f32 v60, v60, v28
v_mul_f32 v61, v61, v28
v_mul_f32 v62, v62, v28
v_mul_f32 v63, v63, v28
s_branch L_fast_0
L_lastprep_1:
s_cmp_lt_u32 s2, 128
s_cbranch_scc1 L_nonext_1
buffer_load_dwordx4 v[160:163], v86, s[36:39], s24 offen offset:0 sc1
buffer_load_dwordx4 v[164:167], v244, s[36:39], s24 offen offset:0 sc1
buffer_load_dwordx4 v[168:171], v87, s[36:39], s25 offen offset:0 sc1
buffer_load_dwordx4 v[172:175], v245, s[36:39], s25 offen offset:0 sc1
s_branch L_nonext_1
L_slow_1:
v_mov_b32 v11, v10
s_nop 1
v_max_f32_dpp v11, v11, v11 row_ror:4 row_mask:0xf bank_mask:0xf
s_nop 1
v_max_f32_dpp v11, v11, v11 row_ror:8 row_mask:0xf bank_mask:0xf
v_mov_b32 v28, v11
s_nop 1
v_permlane16_swap_b32 v11, v28
v_max_f32 v11, v11, v28
v_mov_b32 v28, v11
s_nop 1
v_permlane32_swap_b32 v11, v28
v_max_f32 v11, v11, v28
v_max_f32 v11, v11, v7
v_sub_f32 v28, v7, v11
v_mul_f32 v28, s4, v28
v_exp_f32 v28, v28
v_mov_b32 v7, v11
v_mul_f32 v8, s4, v11
v_mul_f32 v9, v9, v28
v_mul_f32 v32, v32, v28
v_mul_f32 v33, v33, v28
v_mul_f32 v34, v34, v28
v_mul_f32 v35, v35, v28
v_mul_f32 v36, v36, v28
v_mul_f32 v37, v37, v28
v_mul_f32 v38, v38, v28
v_mul_f32 v39, v39, v28
v_mul_f32 v40, v40, v28
v_mul_f32 v41, v41, v28
v_mul_f32 v42, v42, v28
v_mul_f32 v43, v43, v28
v_mul_f32 v44, v44, v28
v_mul_f32 v45, v45, v28
v_mul_f32 v46, v46, v28
v_mul_f32 v47, v47, v28
v_mul_f32 v48, v48, v28
v_mul_f32 v49, v49, v28
v_mul_f32 v50, v50, v28
v_mul_f32 v51, v51, v28
v_mul_f32 v52, v52, v28
v_mul_f32 v53, v53, v28
v_mul_f32 v54, v54, v28
v_mul_f32 v55, v55, v28
v_mul_f32 v56, v56, v28
v_mul_f32 v57, v57, v28
v_mul_f32 v58, v58, v28
v_mul_f32 v59, v59, v28
v_mul_f32 v60, v60, v28
v_mul_f32 v61, v61, v28
v_mul_f32 v62, v62, v28
v_mul_f32 v63, v63, v28
s_branch L_fast_1
L_bdone:
v_add_f32_dpp v9, v9, v9 row_ror:4 row_mask:0xf bank_mask:0xf
s_nop 1
v_add_f32_dpp v9, v9, v9 row_ror:8 row_mask:0xf bank_mask:0xf
v_mov_b32 v240, v9
s_nop 1
v_permlane16_swap_b32 v9, v240
v_add_f32 v9, v9, v240
v_mov_b32 v240, v9
s_nop 1
v_permlane32_swap_b32 v9, v240
v_add_f32 v9, v9, v240
s_mov_b32 exec_lo, 0xf000f
s_mov_b32 exec_hi, 0xf000f
ds_write_b128 v80, v[32:35] offset:18688
ds_write_b128 v80, v[36:39] offset:18704
ds_write_b128 v80, v[40:43] offset:18720
ds_write_b128 v80, v[44:47] offset:18736
ds_write_b128 v80, v[48:51] offset:18752
ds_write_b128 v80, v[52:55] offset:18768
ds_write_b128 v80, v[56:59] offset:18784
ds_write_b128 v80, v[60:63] offset:18800
s_mov_b64 exec, 0xf
ds_write_b32 v81, v7 offset:27264
ds_write_b32 v81, v9 offset:27280
s_mov_b64 exec, -1
s_waitcnt lgkmcnt(0)
s_barrier
ds_read_b128 v[208:211], v82 offset:27136
ds_read_b128 v[212:215], v82 offset:27152
ds_read_b128 v[64:67], v83 offset:10240
ds_read_b128 v[68:71], v83 offset:12352
ds_read_b128 v[72:75], v83 offset:14464
ds_read_b128 v[76:79], v83 offset:16576
s_waitcnt lgkmcnt(4)
v_max3_f32 v246, v208, v209, v210
v_max_f32 v246, v246, v211
v_sub_f32 v248, v208, v246
v_sub_f32 v249, v209, v246
v_sub_f32 v250, v210, v246
v_sub_f32 v251, v211, v246
v_mul_f32 v248, s4, v248
v_mul_f32 v249, s4, v249
v_mul_f32 v250, s4, v250
v_mul_f32 v251, s4, v251
v_exp_f32 v248, v248
v_exp_f32 v249, v249
v_exp_f32 v250, v250
v_exp_f32 v251, v251
v_bfi_b32 v228, s7, v95, v246
v_and_b32 v230, s7, v95
v_and_b32 v231, s7, v95
v_mul_f32 v247, v248, v212
v_fma_f32 v247, v249, v213, v247
v_fma_f32 v247, v250, v214, v247
v_fma_f32 v247, v251, v215, v247
s_waitcnt lgkmcnt(0)
v_mul_f32 v224, v248, v64
v_mul_f32 v225, v248, v65
v_mul_f32 v226, v248, v66
v_mul_f32 v227, v248, v67
v_fma_f32 v224, v249, v68, v224
v_fma_f32 v225, v249, v69, v225
v_fma_f32 v226, v249, v70, v226
v_fma_f32 v227, v249, v71, v227
v_fma_f32 v224, v250, v72, v224
v_fma_f32 v225, v250, v73, v225
v_fma_f32 v226, v250, v74, v226
v_fma_f32 v227, v250, v75, v227
v_fma_f32 v224, v251, v76, v224
v_fma_f32 v225, v251, v77, v225
v_fma_f32 v226, v251, v78, v226
v_fma_f32 v227, v251, v79, v227
v_bfi_b32 v224, s7, v95, v224
v_bfi_b32 v225, s7, v95, v225
v_bfi_b32 v226, s7, v95, v226
v_bfi_b32 v227, s7, v95, v227
buffer_store_dwordx4 v[224:227], v84, s[36:39], 0 offen offset:0 sc1
v_bfi_b32 v229, s7, v95, v247
s_mov_b32 exec_lo, 0x10001
s_mov_b32 exec_hi, 0x10001
buffer_store_dwordx4 v[228:231], v85, s[36:39], 0 offen offset:0 sc1
s_mov_b64 exec, -1
s_cmp_lt_u32 s2, 128
s_cbranch_scc1 L_final
s_mov_b32 s61, 0
s_waitcnt vmcnt(2)
s_branch L_pollc_17
L_poll_16:
buffer_load_dwordx4 v[160:163], v86, s[36:39], s24 offen offset:0 sc1
buffer_load_dwordx4 v[164:167], v244, s[36:39], s24 offen offset:0 sc1
buffer_load_dwordx4 v[168:171], v87, s[36:39], s25 offen offset:0 sc1
buffer_load_dwordx4 v[172:175], v245, s[36:39], s25 offen offset:0 sc1
s_add_u32 s61, s61, 1
s_waitcnt vmcnt(0)
L_pollc_17:
v_xor_b32 v252, s55, v160
v_xor_b32 v253, s55, v161
v_xor_b32 v254, s55, v162
v_or3_b32 v252, v252, v253, v254
v_xor_b32 v253, s55, v163
v_xor_b32 v254, s55, v164
v_or3_b32 v252, v252, v253, v254
v_xor_b32 v253, s55, v165
v_xor_b32 v254, s55, v166
v_or3_b32 v252, v252, v253, v254
v_xor_b32 v253, s55, v167
v_xor_b32 v254, s55, v168
v_or3_b32 v252, v252, v253, v254
v_xor_b32 v253, s55, v169
v_xor_b32 v254, s55, v170
v_or3_b32 v252, v252, v253, v254
v_xor_b32 v253, s55, v171
v_xor_b32 v254, s55, v172
v_or3_b32 v252, v252, v253, v254
v_xor_b32 v253, s55, v173
v_xor_b32 v254, s55, v174
v_or3_b32 v252, v252, v253, v254
v_xor_b32 v253, s55, v175
v_or_b32 v252, v252, v253
v_and_b32 v252, s7, v252
v_cmp_ne_u32 vcc, 0, v252
s_nop 0
s_cbranch_vccz L_polled_18
s_mov_b64 exec, vcc
s_cmp_lt_u32 s61, 200000
s_cbranch_scc1 L_poll_16
L_polled_18:
s_mov_b64 exec, -1
v_and_b32 v168, s6, v168
v_and_b32 v172, s6, v172
v_max_f32 v240, v168, v172
v_mov_b32 v208, v240
s_nop 1
v_permlane16_swap_b32 v240, v208
v_max_f32 v240, v240, v208
v_mov_b32 v208, v240
s_nop 1
v_permlane32_swap_b32 v240, v208
v_max_f32 v240, v240, v208
v_sub_f32 v168, v168, v240
v_sub_f32 v172, v172, v240
v_mul_f32 v168, s4, v168
v_mul_f32 v172, s4, v172
v_exp_f32 v168, v168
v_exp_f32 v172, v172
v_mul_f32 v169, v169, v168
v_mul_f32 v160, v160, v168
v_mul_f32 v161, v161, v168
v_mul_f32 v162, v162, v168
v_mul_f32 v163, v163, v168
v_fma_f32 v169, v173, v172, v169
v_fma_f32 v160, v164, v172, v160
v_fma_f32 v161, v165, v172, v161
v_fma_f32 v162, v166, v172, v162
v_fma_f32 v163, v167, v172, v163
v_mov_b32 v208, v169
v_mov_b32 v209, v160
v_mov_b32 v210, v161
v_mov_b32 v211, v162
v_mov_b32 v212, v163
v_permlane16_swap_b32 v169, v208
v_permlane16_swap_b32 v160, v209
v_permlane16_swap_b32 v161, v210
v_permlane16_swap_b32 v162, v211
v_permlane16_swap_b32 v163, v212
v_add_f32 v169, v169, v208
v_add_f32 v160, v160, v209
v_add_f32 v161, v161, v210
v_add_f32 v162, v162, v211
v_add_f32 v163, v163, v212
v_mov_b32 v208, v169
v_mov_b32 v209, v160
v_mov_b32 v210, v161
v_mov_b32 v211, v162
v_mov_b32 v212, v163
v_permlane32_swap_b32 v169, v208
v_permlane32_swap_b32 v160, v209
v_permlane32_swap_b32 v161, v210
v_permlane32_swap_b32 v162, v211
v_permlane32_swap_b32 v163, v212
v_add_f32 v169, v169, v208
v_add_f32 v160, v160, v209
v_add_f32 v161, v161, v210
v_add_f32 v162, v162, v211
v_add_f32 v163, v163, v212
v_rcp_f32 v169, v169
s_nop 0
v_mul_f32 v160, v160, v169
v_mul_f32 v161, v161, v169
v_mul_f32 v162, v162, v169
v_mul_f32 v163, v163, v169
v_cvt_pk_bf16_f32 v224, v160, v161
v_cvt_pk_bf16_f32 v225, v162, v163
s_mov_b64 exec, 0xffff
ds_write_b64 v88, v[224:225] offset:27392
s_mov_b64 exec, -1
s_waitcnt lgkmcnt(0)
s_barrier
ds_read_b128 v[16:19], v89 offset:27392
ds_read_b128 v[20:23], v89 offset:27456
s_waitcnt lgkmcnt(1)
v_mfma_f32_16x16x32_bf16 v[32:35], v[96:99], v[16:19], 0
v_mfma_f32_16x16x32_bf16 v[36:39], v[100:103], v[16:19], 0
v_mfma_f32_16x16x32_bf16 v[40:43], v[104:107], v[16:19], 0
v_mfma_f32_16x16x32_bf16 v[44:47], v[108:111], v[16:19], 0
v_mfma_f32_16x16x32_bf16 v[48:51], v[112:115], v[16:19], 0
v_mfma_f32_16x16x32_bf16 v[52:55], v[116:119], v[16:19], 0
v_mfma_f32_16x16x32_bf16 v[56:59], v[120:123], v[16:19], 0
v_mfma_f32_16x16x32_bf16 v[60:63], v[124:127], v[16:19], 0
s_waitcnt lgkmcnt(0)
v_mfma_f32_16x16x32_bf16 v[32:35], v[128:131], v[20:23], v[32:35]
v_mfma_f32_16x16x32_bf16 v[36:39], v[132:135], v[20:23], v[36:39]
v_mfma_f32_16x16x32_bf16 v[40:43], v[136:139], v[20:23], v[40:43]
v_mfma_f32_16x16x32_bf16 v[44:47], v[140:143], v[20:23], v[44:47]
v_mfma_f32_16x16x32_bf16 v[48:51], v[144:147], v[20:23], v[48:51]
v_mfma_f32_16x16x32_bf16 v[52:55], v[148:151], v[20:23], v[52:55]
v_mfma_f32_16x16x32_bf16 v[56:59], v[152:155], v[20:23], v[56:59]
v_mfma_f32_16x16x32_bf16 v[60:63], v[156:159], v[20:23], v[60:63]
s_nop 4
v_cndmask_b32 v64, v32, v48, s[84:85]
v_cndmask_b32 v72, v33, v49, s[84:85]
v_cndmask_b32 v65, v36, v52, s[84:85]
v_cndmask_b32 v73, v37, v53, s[84:85]
v_cndmask_b32 v66, v40, v56, s[84:85]
v_cndmask_b32 v74, v41, v57, s[84:85]
v_cndmask_b32 v67, v44, v60, s[84:85]
v_cndmask_b32 v75, v45, v61, s[84:85]
v_cndmask_b32 v208, v64, v72, s[86:87]
v_cndmask_b32 v209, v65, v73, s[86:87]
v_cndmask_b32 v210, v66, v74, s[86:87]
v_cndmask_b32 v211, v67, v75, s[86:87]
v_bfi_b32 v208, s7, v95, v208
v_bfi_b32 v209, s7, v95, v209
v_bfi_b32 v210, s7, v95, v210
v_bfi_b32 v211, s7, v95, v211
buffer_store_dwordx4 v[208:211], v90, s[36:39], s26 offen offset:0 sc1
v_cndmask_b32 v68, v34, v50, s[84:85]
v_cndmask_b32 v76, v35, v51, s[84:85]
v_cndmask_b32 v69, v38, v54, s[84:85]
v_cndmask_b32 v77, v39, v55, s[84:85]
v_cndmask_b32 v70, v42, v58, s[84:85]
v_cndmask_b32 v78, v43, v59, s[84:85]
v_cndmask_b32 v71, v46, v62, s[84:85]
v_cndmask_b32 v79, v47, v63, s[84:85]
v_cndmask_b32 v212, v68, v76, s[86:87]
v_cndmask_b32 v213, v69, v77, s[86:87]
v_cndmask_b32 v214, v70, v78, s[86:87]
v_cndmask_b32 v215, v71, v79, s[86:87]
v_bfi_b32 v212, s7, v95, v212
v_bfi_b32 v213, s7, v95, v213
v_bfi_b32 v214, s7, v95, v214
v_bfi_b32 v215, s7, v95, v215
buffer_store_dwordx4 v[212:215], v91, s[36:39], s26 offen offset:0 sc1
s_branch L_fin
L_final:
s_mov_b32 s61, 0
L_poll_19:
buffer_load_dwordx4 v[128:131], v3, s[36:39], s27 offen offset:0 sc1
buffer_load_dwordx4 v[132:135], v3, s[36:39], s27 offen offset:1024 sc1
s_add_u32 s61, s61, 1
s_waitcnt vmcnt(0)
L_pollc_20:
v_xor_b32 v252, s55, v128
v_xor_b32 v253, s55, v129
v_xor_b32 v254, s55, v130
v_or3_b32 v252, v252, v253, v254
v_xor_b32 v253, s55, v131
v_xor_b32 v254, s55, v132
v_or3_b32 v252, v252, v253, v254
v_xor_b32 v253, s55, v133
v_xor_b32 v254, s55, v134
v_or3_b32 v252, v252, v253, v254
v_xor_b32 v253, s55, v135
v_or_b32 v252, v252, v253
v_and_b32 v252, s7, v252
v_cmp_ne_u32 vcc, 0, v252
s_nop 0
s_cbranch_vccz L_polled_21
s_mov_b64 exec, vcc
s_cmp_lt_u32 s61, 200000
s_cbranch_scc1 L_poll_19
L_polled_21:
s_mov_b64 exec, -1
v_add_f32 v128, v128, v132
v_add_f32 v129, v129, v133
v_add_f32 v130, v130, v134
v_add_f32 v131, v131, v135
v_add_f32_dpp v128, v128, v128 row_ror:4 row_mask:0xf bank_mask:0xf
v_add_f32_dpp v129, v129, v129 row_ror:4 row_mask:0xf bank_mask:0xf
v_add_f32_dpp v130, v130, v130 row_ror:4 row_mask:0xf bank_mask:0xf
v_add_f32_dpp v131, v131, v131 row_ror:4 row_mask:0xf bank_mask:0xf
v_add_f32_dpp v128, v128, v128 row_ror:8 row_mask:0xf bank_mask:0xf
v_add_f32_dpp v129, v129, v129 row_ror:8 row_mask:0xf bank_mask:0xf
v_add_f32_dpp v130, v130, v130 row_ror:8 row_mask:0xf bank_mask:0xf
v_add_f32_dpp v131, v131, v131 row_ror:8 row_mask:0xf bank_mask:0xf
s_mov_b32 exec_lo, 0xf000f
s_mov_b32 exec_hi, 0xf000f
ds_write_b128 v92, v[128:131] offset:27904
s_mov_b64 exec, -1
s_waitcnt lgkmcnt(0)
s_barrier
s_cmp_lg_u32 s3, 0
s_cbranch_scc1 L_fin
ds_read_b32 v208, v93 offset:27904
ds_read_b32 v209, v93 offset:27968
ds_read_b32 v210, v93 offset:28032
ds_read_b32 v211, v93 offset:28096
ds_read_b32 v212, v93 offset:28160
ds_read_b32 v213, v93 offset:28224
ds_read_b32 v214, v93 offset:28288
ds_read_b32 v215, v93 offset:28352
ds_read_b32 v216, v93 offset:28416
ds_read_b32 v217, v93 offset:28480
ds_read_b32 v218, v93 offset:28544
ds_read_b32 v219, v93 offset:28608
ds_read_b32 v220, v93 offset:28672
ds_read_b32 v221, v93 offset:28736
ds_read_b32 v222, v93 offset:28800
ds_read_b32 v223, v93 offset:28864
s_waitcnt lgkmcnt(0)
v_add_f32 v208, v208, v209
v_add_f32 v210, v210, v211
v_add_f32 v212, v212, v213
v_add_f32 v214, v214, v215
v_add_f32 v216, v216, v217
v_add_f32 v218, v218, v219
v_add_f32 v220, v220, v221
v_add_f32 v222, v222, v223
v_add_f32 v208, v208, v210
v_add_f32 v212, v212, v214
v_add_f32 v216, v216, v218
v_add_f32 v220, v220, v222
v_add_f32 v208, v208, v212
v_add_f32 v216, v216, v220
v_cvt_pk_bf16_f32 v208, v208, v216
v_and_b32 v216, s6, v208
v_lshlrev_b32 v208, 16, v208
v_mul_f32 v208, s97, v208
v_mul_f32 v216, s98, v216
v_cvt_pk_bf16_f32 v208, v208, v216
v_and_b32 v216, s6, v208
v_lshlrev_b32 v208, 16, v208
v_add_f32 v208, v208, v216
v_cvt_pk_bf16_f32 v208, v208, v208
s_mov_b32 exec_lo, 0xffff
s_mov_b32 exec_hi, 0x0
buffer_store_short v208, v94, s[40:43], s44 offen sc1
s_mov_b64 exec, -1
s_cmp_lg_u32 s2, 0
s_cbranch_scc1 L_fin
v_mov_b32 v28, 0
s_mov_b32 exec_lo, 0x1
s_mov_b32 exec_hi, 0x0
buffer_store_dword v95, v28, s[36:39], 0 offen offset:0 sc1
s_mov_b64 exec, -1
L_fin:
L_end:
s_endpgm
.section .rodata,"a"
.p2align 6
.amdhsa_kernel gated_mix__sliding_block_cached__gqa_block_cached__decode_kernel
  .amdhsa_next_free_vgpr 452
  .amdhsa_next_free_sgpr 102
  .amdhsa_accum_offset 256
  .amdhsa_group_segment_fixed_size 0
  .amdhsa_kernarg_size 112
  .amdhsa_user_sgpr_count 2
  .amdhsa_user_sgpr_kernarg_segment_ptr 1
  .amdhsa_system_sgpr_workgroup_id_x 1
.end_amdhsa_kernel
```
